```python
import torch

def _softmax(x, axis=-1):
    return torch.softmax(x, dim=axis)
def _gelu(x):
    return torch.nn.functional.gelu(x, approximate="tanh")
def _silu(x):
    return torch.nn.functional.silu(x)
def _sigmoid(x):
    return torch.sigmoid(x)
def _layernorm(x, axis=-1, eps=1e-5):
    m = x.mean(dim=axis, keepdim=True)
    v = x.var(dim=axis, keepdim=True, unbiased=False)
    return (x - m) / torch.sqrt(v + eps)
def _scatter_add(tgt, idx, src, axis=0):
    return tgt.clone().index_add_(axis, idx, src)
def _segment_sum(src, seg, n):
    out = torch.zeros((n,) + src.shape[1:], dtype=src.dtype)
    return out.index_add_(0, seg, src)
def _pad(x, pw):
    flat = tuple(v for pair in reversed(pw) for v in pair)
    return torch.nn.functional.pad(x, flat)

kernel_name = 'standalone__seq2seq_rnn_t_joint__speech'

def setup_inputs():

    _w = (lambda a: (lambda t: t.to(torch.bfloat16) if t.is_floating_point() else t)(torch.as_tensor(a)))
    B, T, D, K = 2, 4000, 144, 31
    U = 8
    sc = (1.0 / (K * D)) ** 0.5
    sd = (1.0 / D) ** 0.5
    return {
        "x": _w((lambda *s: torch.randn(*s, dtype=torch.bfloat16) * 0.2)(B, T, D) * 0.5),
        "w1": _w((lambda *s: torch.randn(*s, dtype=torch.bfloat16) * 3.2)(K, D, D) * sc),
        "w2": _w((lambda *s: torch.randn(*s, dtype=torch.bfloat16) * 3.2)(K, D, D) * sc),
        "g": _w((lambda *s: torch.randn(*s, dtype=torch.bfloat16) * 3.2)(B, U, D) * 0.5),
        "w_f": _w((lambda *s: torch.randn(*s, dtype=torch.bfloat16) * 3.2)(D, D) * sd),
        "w_g": _w((lambda *s: torch.randn(*s, dtype=torch.bfloat16) * 3.2)(D, D) * sd),
        "w_o": _w((lambda *s: torch.randn(*s, dtype=torch.bfloat16) * 3.2)(D, D) * sd),
    }

def reference(x, w1, w2, g, w_f, w_g, w_o):
    B, T, D = x.shape
    K = w1.shape[0]
    pad = K // 2
    xp = _pad(x, ((0,0),(pad,pad),(0,0)))
    h = torch.zeros_like(x)
    for i in range(K):
        h = h + torch.einsum("btc,cd->btd", xp[:, i:i+T, :], w1[i])
    h = _gelu(h)[:, ::2, :]
    T1 = h.shape[1]
    hp = _pad(h, ((0,0),(pad,pad),(0,0)))
    f = torch.zeros_like(h)
    for i in range(K):
        f = f + torch.einsum("btc,cd->btd", hp[:, i:i+T1, :], w2[i])
    f = _gelu(f)[:, ::2, :]
    fe = torch.einsum("btd,de->bte", f, w_f)
    ge = torch.einsum("bud,de->bue", g, w_g)
    j = torch.tanh(fe[:, :, None, :] + ge[:, None, :, :])
    return torch.einsum("btud,dv->btuv", j, w_o)
```

```asm
; @launch grid=(252,1,1) block=(512,1,1) lds=163840
.amdgcn_target "amdgcn-amd-amdhsa--gfx950"
.text
.globl standalone__seq2seq_rnn_t_joint__speech_kernel
.p2align 12
.p2align 8
.type standalone__seq2seq_rnn_t_joint__speech_kernel,@function
standalone__seq2seq_rnn_t_joint__speech_kernel:
    s_cmpk_ge_u32 s2, 252
    s_cbranch_scc1 L_end
    s_load_dwordx2 s[4:5], s[0:1], 0
    s_load_dwordx2 s[8:9], s[0:1], 8
    v_lshrrev_b32 v1, 6, v0
    s_lshr_b32 s49, s2, 3
    s_and_b32 s48, s49, 15
    v_readfirstlane_b32 s46, v1
    s_mul_i32 s48, s48, 9
    s_lshr_b32 s50, s49, 4
    s_add_u32 s48, s48, s50
    s_mulk_i32 s48, 9216
    s_addk_i32 s48, -4608
    v_lshl_add_u32 v2, v0, 7, s48
    v_cmp_gt_u32 vcc, 72, v0
    v_and_b32 v0, 63, v0
    s_lshl_b32 s48, s2, 2
    s_lshr_b32 s50, 0x55554442, s48
    s_and_b32 s50, s50, 15
    s_lshl1_add_u32 s16, s50, 16
    s_bfm_b64 s[56:57], s16, 0
    s_and_b32 s56, s56, 0x5555ffff
    s_lshl_b32 s48, s2, 3
    s_mov_b32 s50, 0x3a261200
    s_mov_b32 s51, 0x8d78634e
    s_lshr_b64 s[50:51], s[50:51], s48
    s_and_b32 s17, s50, 255
    s_bfm_b32 s50, s49, 0
    s_and_b32 s50, s50, s56
    s_bcnt1_i32_b32 s50, s50
    s_add_u32 s48, s17, s50
    s_sub_u32 s57, s49, s50
    s_lshr_b32 s56, s56, s49
    s_mul_i32 s44, s48, 7282
    s_lshr_b32 s44, s44, 16
    s_mul_i32 s49, s44, 9
    s_sub_u32 s45, s48, s49
    s_and_b32 s47, s46, 3
    s_mov_b32 s6, 1152000
    s_mov_b32 s7, 0x20000
    s_mov_b32 s10, 1285632
    s_mov_b32 s11, s7
    s_cmp_gt_u32 s44, 8
    s_cselect_b32 s52, s6, 0
    s_cselect_b32 s49, 1020, 12
    s_mul_i32 s48, s44, 112
    s_sub_u32 s48, s48, s49
    s_lshl3_add_u32 s48, s47, s48
    v_lshrrev_b32 v3, 3, v0
    v_add_u32 v3, s48, v3
    v_and_b32 v4, 7, v0
    v_lshlrev_b32 v4, 4, v4
    s_movk_i32 s53, 1152
    v_mad_i32_i24 v28, v3, s53, v4
    s_lshl_b32 s53, s53, 5
    s_mul_i32 s54, s47, -9216
    s_add_u32 s54, s54, s53
    s_lshl_b32 s55, s47, 4
    s_bfm_b64 s[58:59], 16, s55
    s_mul_i32 s60, s47, 1056
    s_cmp_lt_u32 s46, 4
    s_cselect_b32 s48, 3, 1
    s_cselect_b32 s49, 120960, 0
    s_lshl_b32 s48, s48, 8
    s_addk_i32 s49, 16736
    s_add_u32 m0, s49, s60
    s_addk_i32 s49, 16896
    s_mov_b64 exec, vcc
    s_bitcmp0_b32 s56, 0
    s_waitcnt lgkmcnt(0)
    buffer_load_dword v1, v2, s[8:11], 0 offen
    s_mov_b64 exec, -1
    s_cbranch_scc1 L_help
    s_add_u32 s4, s4, s52
    s_addc_u32 s5, s5, 0
    buffer_load_dwordx4 v28, s[4:7], s48 offen lds
    s_addk_i32 m0, 4224
    v_add_u32 v29, s53, v28
    buffer_load_dwordx4 v29, s[4:7], s48 offen lds
    s_addk_i32 m0, 4224
    v_add_u32 v30, s53, v29
    buffer_load_dwordx4 v30, s[4:7], s48 offen lds
    s_addk_i32 m0, 4224
    v_add_u32 v31, s53, v30
    buffer_load_dwordx4 v31, s[4:7], s48 offen lds
    s_mov_b32 m0, s49
    v_add_u32 v32, s54, v31
    s_mov_b64 exec, s[58:59]
    buffer_load_dwordx4 v32, s[4:7], s48 offen lds
    s_mov_b64 exec, -1
    s_cmp_lt_u32 s46, 4
    s_cbranch_scc1 L_cw
L_p512:
    v_and_b32 v4, 24, v0
    v_lshrrev_b32 v5, 5, v0
    v_lshl_add_u32 v4, v5, 2, v4
    v_bfe_u32 v5, v0, 1, 2
    v_add_u32 v4, v4, v5
    v_mul_u32_u24 v26, 288, v4
    v_and_b32 v5, 1, v0
    v_lshl_add_u32 v26, v5, 4, v26
    s_mul_i32 s48, s47, 82944
    s_lshl_b32 s49, s45, 5
    s_add_u32 s48, s48, s49
    v_add_u32 v26, s48, v26
    v_subrev_u32 v3, 4608, v26
    s_lshl_b32 s62, s47, 10
    v_min_u32 v3, 0x80000000, v3
    s_add_u32 m0, s62, 52640
    s_nop 0
    buffer_load_dwordx4 v3, s[8:11], 0 offen lds
    s_add_u32 m0, s62, 56736
    s_mov_b32 s48, 327168
    buffer_load_dwordx4 v26, s[8:11], s48 offen lds
    s_add_u32 m0, s62, 60832
    s_mov_b32 s48, 658944
    buffer_load_dwordx4 v26, s[8:11], s48 offen lds
    s_add_u32 m0, s62, 64928
    s_mov_b32 s48, 990720
    buffer_load_dwordx4 v26, s[8:11], s48 offen lds
    s_movk_i32 s49, 896
    s_add_u32 m0, s62, 86976
    s_mov_b32 s48, 4608
    buffer_load_dwordx4 v26, s[8:11], s48 offen lds
    s_add_u32 m0, s60, 34688
    s_nop 0
    buffer_load_dwordx4 v28, s[4:7], s49 offen lds
    s_add_u32 m0, s62, 91072
    s_mov_b32 s48, 336384
    buffer_load_dwordx4 v26, s[8:11], s48 offen lds
    s_load_dwordx2 s[12:13], s[0:1], 16
    s_mov_b32 s14, 1285632
    s_mov_b32 s15, s7
    s_load_dwordx2 s[20:21], s[0:1], 32
    s_mov_b32 s22, 41472
    s_mov_b32 s23, s7
    s_load_dwordx2 s[28:29], s[0:1], 48
    s_mov_b32 s30, 41472
    s_mov_b32 s31, s7
    s_load_dwordx2 s[32:33], s[0:1], 56
    s_mov_b32 s34, 2304000
    s_mov_b32 s35, s7
    s_load_dwordx2 s[36:37], s[0:1], 64
    s_mov_b32 s38, 256
    s_mov_b32 s39, s7
    s_load_dwordx2 s[40:41], s[0:1], 72
    s_mov_b32 s42, 6179328
    s_mov_b32 s43, s7
    s_and_b32 s51, s47, 1
    s_lshl_b32 s50, s51, 5
    s_lshl_b32 s51, s51, 8
    s_add_u32 s48, s50, 41472
    s_sub_u32 s49, 41728, s51
    v_lshrrev_b32 v1, 4, v0
    v_and_b32 v10, 15, v0
    v_lshlrev_b32 v10, 4, v10
    v_mul_u32_u24 v4, 1152, v1
    v_add3_u32 v14, v4, v10, s48
    v_add_u32 v8, v4, v14
    v_and_b32 v5, 7, v0
    v_mul_u32_u24 v5, 288, v5
    v_bfe_u32 v6, v0, 3, 1
    v_lshl_add_u32 v5, v6, 4, v5
    v_add3_u32 v15, v4, v5, s49
    v_add_u32 v9, v4, v15
    v_and_b32 v5, 1, v1
    v_mul_u32_u24 v5, 1144, v5
    v_sub_u32 v15, v15, v5
    v_sub_u32 v14, v14, v5
    s_cmp_gt_u32 s44, 8
    s_cselect_b32 s63, 9, 0
    s_sub_u32 s48, s44, s63
    s_lshl_b32 s48, s48, 1
    s_and_b32 s49, s45, 1
    s_add_u32 s48, s48, s49
    s_mul_i32 s48, s48, 56
    s_lshr_b32 s49, s45, 1
    s_add_u32 s48, s48, s49
    s_lshl3_add_u32 s48, s48, s47
    s_mul_i32 s48, s48, 288
    s_add_u32 s50, s48, s50
    s_sub_u32 s51, s48, s51
    v_and_b32 v5, 7, v0
    v_bfe_u32 v6, v0, 3, 1
    v_mul_u32_u24 v3, 16128, v5
    v_mul_u32_u24 v7, 1152, v6
    v_add3_u32 v3, v3, v7, s51
    v_lshl_add_u32 v3, v1, 3, v3
    v_lshlrev_b32 v2, 7, v1
    s_lshl4_add_u32 s48, s47, 147456
    v_lshl_add_u32 v18, v6, 6, s48
    v_add_u32 v18, v2, v18
    v_lshl_add_u32 v2, v5, 4, v2
    v_add_u32 v20, 126976, v2
    v_lshrrev_b32 v21, 1, v2
    v_add_u32 v21, 129024, v21
    v_lshrrev_b32 v19, 2, v0
    v_mul_u32_u24 v19, 288, v19
    v_and_b32 v7, 3, v0
    v_lshl_add_u32 v19, v7, 3, v19
    v_add_u32 v2, 131072, v2
    v_lshlrev_b32 v12, 6, v6
    v_lshl_add_u32 v12, v5, 3, v12
    v_and_b32 v13, 1, v1
    v_lshl_add_u32 v12, v13, 7, v12
    v_add_u32 v12, 129024, v12
    v_mul_u32_u24 v6, 2304, v1
    v_mul_u32_u24 v7, 64512, v13
    v_lshrrev_b32 v1, 1, v1
    v_mul_u32_u24 v1, 1152, v1
    v_add3_u32 v1, v1, v7, s50
    v_add_u32 v1, v1, v10
    v_add_u32 v10, 2048, v10
    v_lshl_add_u32 v13, v13, 3, v10
    v_cmp_gt_u32 vcc, 16, v0
    v_bfrev_b32 v7, 1
    s_nop 0
    v_cndmask_b32 v11, v7, v10, vcc
    v_add_u32 v10, v6, v10
    v_mov_b32 v27, 0
    v_and_b32 v55, 1, v5
    v_lshlrev_b32 v55, 4, v55
    s_movk_i32 s48, 0x3f80
    v_lshlrev_b32 v55, v55, s48
    v_lshrrev_b32 v5, 1, v5
    v_cmp_eq_u32 vcc, 0, v5
    s_nop 1
    v_cndmask_b32 v52, 0, v55, vcc
    v_cmp_eq_u32 vcc, 1, v5
    s_nop 1
    v_cndmask_b32 v53, 0, v55, vcc
    v_cmp_eq_u32 vcc, 2, v5
    s_nop 1
    v_cndmask_b32 v54, 0, v55, vcc
    v_cmp_eq_u32 vcc, 3, v5
    s_nop 1
    v_cndmask_b32 v55, 0, v55, vcc
    s_cmp_gt_u32 s45, 11
    s_cselect_b32 s48, 1, 0
    s_cselect_b32 s49, 0, 0
    s_lshl2_add_u32 s48, s48, 1156
    s_lshl2_add_u32 s49, s49, 2304
    s_cmp_gt_u32 s45, 8
    s_cselect_b32 s48, s48, 1152
    s_cselect_b32 s49, s49, 0
    s_mul_i32 s56, s44, 9
    s_sub_u32 s56, s56, s17
    s_lshr_b32 s16, s16, 1
    s_add_u32 s16, s16, 8
    v_add_u32 v5, s56, v0
    v_cmp_gt_u32 vcc, s16, v5
    v_lshl_add_u32 v5, v0, 7, s48
    v_lshl_add_u32 v22, v0, 7, s49
    v_cndmask_b32 v22, v22, v5, vcc
    s_mul_i32 s48, s44, 14
    s_add_u32 s48, s48, s45
    s_mul_i32 s16, s48, 20736
    s_add_u32 s17, s16, 9216
    s_add_u32 s18, s16, 18432
    v_mov_b32 v56, 0xc0135761
    v_mov_b32 v57, v56
    s_mov_b32 s63, 0
    s_cmp_eq_u32 s47, 0
    s_cselect_b32 s56, 0x1ff, 0
    s_bitset0_b32 s56, s45
    s_mov_b32 s57, 0
    v_and_b32 v24, 24, v0
    v_lshrrev_b32 v25, 5, v0
    v_lshl_add_u32 v24, v25, 2, v24
    v_and_b32 v25, 7, v0
    v_lshl_add_u32 v24, v24, 2, v25
    v_lshlrev_b32 v24, 4, v24
    v_lshlrev_b32 v25, 2, v0
    v_add_u32 v25, 152576, v25
    v_add_u32 v33, 1152, v28
    v_add_u32 v34, 1152, v29
    v_add_u32 v35, 1152, v30
    v_add_u32 v36, 1152, v31
    v_add_u32 v37, 1152, v32
    v_lshlrev_b32 v42, 4, v0
    s_mul_i32 s52, s47, 10368
    v_add_u32 v42, s52, v42
    v_bfrev_b32 v7, 1
    v_min_u32 v28, v7, v28
    s_mul_i32 s48, s45, 4608
    s_mul_i32 s49, s47, 82944
    s_add_u32 s48, s48, s49
    v_lshlrev_b32 v38, 4, v0
    v_add_u32 v38, s48, v38
    v_lshrrev_b32 v4, 5, v0
    v_mul_u32_u24 v4, 36864, v4
    v_add_u32 v40, 4096, v38
    v_add_u32 v40, v4, v40
    v_subrev_u32 v39, 41472, v38
    v_subrev_u32 v41, 41472, v40
    s_cmp_eq_u32 s47, 0
    s_cselect_b64 vcc, -1, 0
    v_cndmask_b32 v39, v39, v7, vcc
    s_mov_b32 vcc_hi, 0
    v_cndmask_b32 v41, v41, v7, vcc
    s_mul_i32 s53, s47, 9216
    s_waitcnt vmcnt(3)
    s_barrier
    s_movk_i32 s49, 896
    s_add_u32 m0, s60, 38912
    s_nop 0
    buffer_load_dwordx4 v29, s[4:7], s49 offen lds
    s_add_u32 m0, s62, 95168
    s_mov_b32 s48, 668160
    buffer_load_dwordx4 v26, s[8:11], s48 offen lds
    s_add_u32 m0, s60, 43136
    s_nop 0
    buffer_load_dwordx4 v30, s[4:7], s49 offen lds
    s_add_u32 m0, s62, 99264
    s_mov_b32 s48, 999936
    buffer_load_dwordx4 v26, s[8:11], s48 offen lds
    s_add_u32 m0, s60, 47360
    s_nop 0
    buffer_load_dwordx4 v31, s[4:7], s49 offen lds
    s_mov_b32 m0, 51584
    s_mov_b64 exec, s[58:59]
    buffer_load_dwordx4 v32, s[4:7], s49 offen lds
    s_mov_b64 exec, -1
    s_movk_i32 s49, 384
    s_add_u32 m0, s62, 121312
    s_mov_b32 s48, 13824
    buffer_load_dwordx4 v26, s[8:11], s48 offen lds
    s_add_u32 m0, s60, 69024
    s_nop 0
    buffer_load_dwordx4 v28, s[4:7], s49 offen lds
    s_add_u32 m0, s62, 125408
    s_mov_b32 s48, 345600
    buffer_load_dwordx4 v26, s[8:11], s48 offen lds
    s_waitcnt vmcnt(3) lgkmcnt(0)
    s_barrier
    s_movk_i32 s49, 384
    s_add_u32 m0, s60, 73248
    s_nop 0
    buffer_load_dwordx4 v29, s[4:7], s49 offen lds
    s_add_u32 m0, s62, 129504
    s_mov_b32 s48, 677376
    buffer_load_dwordx4 v26, s[8:11], s48 offen lds
    s_add_u32 m0, s60, 77472
    s_nop 0
    buffer_load_dwordx4 v30, s[4:7], s49 offen lds
    s_add_u32 m0, s62, 133600
    s_mov_b32 s48, 1009152
    buffer_load_dwordx4 v26, s[8:11], s48 offen lds
    s_add_u32 m0, s60, 81696
    s_nop 0
    buffer_load_dwordx4 v31, s[4:7], s49 offen lds
    s_mov_b32 m0, 85920
    s_mov_b64 exec, s[58:59]
    buffer_load_dwordx4 v32, s[4:7], s49 offen lds
    s_mov_b64 exec, -1
    s_movk_i32 s49, 1024
    s_add_u32 m0, s62, 52640
    s_mov_b32 s48, 23040
    buffer_load_dwordx4 v26, s[8:11], s48 offen lds
    s_add_u32 m0, s60, 103360
    s_nop 0
    buffer_load_dwordx4 v28, s[4:7], s49 offen lds
    s_add_u32 m0, s62, 56736
    s_mov_b32 s48, 354816
    buffer_load_dwordx4 v26, s[8:11], s48 offen lds
    s_waitcnt vmcnt(3) lgkmcnt(0)
    s_barrier
    s_movk_i32 s49, 1024
    s_add_u32 m0, s60, 107584
    s_nop 0
    buffer_load_dwordx4 v29, s[4:7], s49 offen lds
    s_add_u32 m0, s62, 60832
    s_mov_b32 s48, 686592
    buffer_load_dwordx4 v26, s[8:11], s48 offen lds
    s_add_u32 m0, s60, 111808
    s_nop 0
    buffer_load_dwordx4 v30, s[4:7], s49 offen lds
    s_add_u32 m0, s62, 64928
    s_mov_b32 s48, 1018368
    buffer_load_dwordx4 v26, s[8:11], s48 offen lds
    s_add_u32 m0, s60, 116032
    s_nop 0
    buffer_load_dwordx4 v31, s[4:7], s49 offen lds
    s_mov_b32 m0, 120256
    s_mov_b64 exec, s[58:59]
    buffer_load_dwordx4 v32, s[4:7], s49 offen lds
    s_mov_b64 exec, -1
    s_movk_i32 s49, 512
    s_add_u32 m0, s62, 86976
    s_mov_b32 s48, 32256
    buffer_load_dwordx4 v26, s[8:11], s48 offen lds
    s_add_u32 m0, s60, 16736
    s_nop 0
    buffer_load_dwordx4 v28, s[4:7], s49 offen lds
    s_add_u32 m0, s62, 91072
    s_mov_b32 s48, 364032
    buffer_load_dwordx4 v26, s[8:11], s48 offen lds
    s_waitcnt vmcnt(3) lgkmcnt(0)
    s_barrier
    s_movk_i32 s49, 512
    s_add_u32 m0, s60, 20960
    s_nop 0
    buffer_load_dwordx4 v29, s[4:7], s49 offen lds
    s_add_u32 m0, s62, 95168
    s_mov_b32 s48, 695808
    buffer_load_dwordx4 v26, s[8:11], s48 offen lds
    s_add_u32 m0, s60, 25184
    s_nop 0
    buffer_load_dwordx4 v30, s[4:7], s49 offen lds
    s_add_u32 m0, s62, 99264
    s_mov_b32 s48, 1027584
    buffer_load_dwordx4 v26, s[8:11], s48 offen lds
    s_add_u32 m0, s60, 29408
    s_nop 0
    buffer_load_dwordx4 v31, s[4:7], s49 offen lds
    s_mov_b32 m0, 33632
    s_mov_b64 exec, s[58:59]
    buffer_load_dwordx4 v32, s[4:7], s49 offen lds
    s_mov_b64 exec, -1
    s_movk_i32 s49, 0
    s_add_u32 m0, s62, 121312
    s_mov_b32 s48, 41472
    buffer_load_dwordx4 v26, s[8:11], s48 offen lds
    s_add_u32 m0, s60, 34688
    s_nop 0
    buffer_load_dwordx4 v33, s[4:7], s49 offen lds
    s_add_u32 m0, s62, 125408
    s_mov_b32 s48, 373248
    buffer_load_dwordx4 v26, s[8:11], s48 offen lds
    s_waitcnt vmcnt(3) lgkmcnt(0)
    s_barrier
    s_movk_i32 s49, 0
    s_add_u32 m0, s60, 38912
    s_nop 0
    buffer_load_dwordx4 v34, s[4:7], s49 offen lds
    s_add_u32 m0, s62, 129504
    s_mov_b32 s48, 705024
    buffer_load_dwordx4 v26, s[8:11], s48 offen lds
    s_add_u32 m0, s60, 43136
    s_nop 0
    buffer_load_dwordx4 v35, s[4:7], s49 offen lds
    s_add_u32 m0, s62, 133600
    s_mov_b32 s48, 1036800
    buffer_load_dwordx4 v26, s[8:11], s48 offen lds
    s_add_u32 m0, s60, 47360
    s_nop 0
    buffer_load_dwordx4 v36, s[4:7], s49 offen lds
    s_mov_b32 m0, 51584
    s_mov_b64 exec, s[58:59]
    buffer_load_dwordx4 v37, s[4:7], s49 offen lds
    s_mov_b64 exec, -1
    s_movk_i32 s49, 640
    s_add_u32 m0, s62, 52640
    s_mov_b32 s48, 50688
    buffer_load_dwordx4 v26, s[8:11], s48 offen lds
    s_add_u32 m0, s60, 69024
    s_nop 0
    buffer_load_dwordx4 v28, s[4:7], s49 offen lds
    s_add_u32 m0, s62, 56736
    s_mov_b32 s48, 382464
    buffer_load_dwordx4 v26, s[8:11], s48 offen lds
    s_waitcnt vmcnt(3) lgkmcnt(0)
    s_barrier
    s_movk_i32 s49, 640
    s_add_u32 m0, s60, 73248
    s_nop 0
    buffer_load_dwordx4 v29, s[4:7], s49 offen lds
    s_add_u32 m0, s62, 60832
    s_mov_b32 s48, 714240
    buffer_load_dwordx4 v26, s[8:11], s48 offen lds
    s_add_u32 m0, s60, 77472
    s_nop 0
    buffer_load_dwordx4 v30, s[4:7], s49 offen lds
    s_add_u32 m0, s62, 64928
    s_mov_b32 s48, 1046016
    buffer_load_dwordx4 v26, s[8:11], s48 offen lds
    s_add_u32 m0, s60, 81696
    s_nop 0
    buffer_load_dwordx4 v31, s[4:7], s49 offen lds
    s_mov_b32 m0, 85920
    s_mov_b64 exec, s[58:59]
    buffer_load_dwordx4 v32, s[4:7], s49 offen lds
    s_mov_b64 exec, -1
    s_movk_i32 s49, 128
    s_add_u32 m0, s62, 86976
    s_mov_b32 s48, 59904
    buffer_load_dwordx4 v26, s[8:11], s48 offen lds
    s_add_u32 m0, s60, 103360
    s_nop 0
    buffer_load_dwordx4 v33, s[4:7], s49 offen lds
    s_add_u32 m0, s62, 91072
    s_mov_b32 s48, 391680
    buffer_load_dwordx4 v26, s[8:11], s48 offen lds
    s_waitcnt vmcnt(3) lgkmcnt(0)
    s_barrier
    s_movk_i32 s49, 128
    s_add_u32 m0, s60, 107584
    s_nop 0
    buffer_load_dwordx4 v34, s[4:7], s49 offen lds
    s_add_u32 m0, s62, 95168
    s_mov_b32 s48, 723456
    buffer_load_dwordx4 v26, s[8:11], s48 offen lds
    s_add_u32 m0, s60, 111808
    s_nop 0
    buffer_load_dwordx4 v35, s[4:7], s49 offen lds
    s_add_u32 m0, s62, 99264
    s_mov_b32 s48, 1055232
    buffer_load_dwordx4 v26, s[8:11], s48 offen lds
    s_add_u32 m0, s60, 116032
    s_nop 0
    buffer_load_dwordx4 v36, s[4:7], s49 offen lds
    s_mov_b32 m0, 120256
    s_mov_b64 exec, s[58:59]
    buffer_load_dwordx4 v37, s[4:7], s49 offen lds
    s_mov_b64 exec, -1
    s_add_u32 m0, s62, 121312
    s_mov_b32 s48, 69120
    buffer_load_dwordx4 v26, s[8:11], s48 offen lds
    s_add_u32 m0, s62, 125408
    s_mov_b32 s48, 400896
    buffer_load_dwordx4 v26, s[8:11], s48 offen lds
    s_add_u32 m0, s62, 129504
    s_mov_b32 s48, 732672
    buffer_load_dwordx4 v26, s[8:11], s48 offen lds
    s_waitcnt vmcnt(3) lgkmcnt(0)
    s_barrier
    s_add_u32 m0, s62, 133600
    s_mov_b32 s48, 1064448
    buffer_load_dwordx4 v26, s[8:11], s48 offen lds
    s_add_u32 m0, s53, 0
    s_nop 0
    buffer_load_dwordx4 v39, s[12:15], 0 offen lds
    buffer_load_dwordx4 v39, s[12:15], 0 offen offset:1024 lds
    buffer_load_dwordx4 v39, s[12:15], 0 offen offset:2048 lds
    buffer_load_dwordx4 v39, s[12:15], 0 offen offset:3072 lds
    s_add_u32 m0, s53, 4096
    s_nop 0
    buffer_load_dwordx4 v41, s[12:15], 0 offen lds
    s_add_u32 m0, s53, 5120
    s_mov_b32 s48, 512
    buffer_load_dwordx4 v38, s[12:15], s48 offen lds
    buffer_load_dwordx4 v38, s[12:15], s48 offen offset:1024 lds
    buffer_load_dwordx4 v38, s[12:15], s48 offen offset:2048 lds
    s_branch L_povr0
L_pad0:
    s_branch L_back
L_povr0:
    buffer_load_dwordx4 v38, s[12:15], s48 offen offset:3072 lds
    s_waitcnt vmcnt(9)
    s_barrier
    s_mov_b32 s48, 290304
    s_add_u32 m0, s53, 36864
    s_nop 0
    buffer_load_dwordx4 v38, s[12:15], s48 offen lds
    buffer_load_dwordx4 v38, s[12:15], s48 offen offset:1024 lds
    buffer_load_dwordx4 v38, s[12:15], s48 offen offset:2048 lds
    buffer_load_dwordx4 v38, s[12:15], s48 offen offset:3072 lds
    s_add_u32 m0, s53, 40960
    s_nop 0
    buffer_load_dwordx4 v40, s[12:15], s48 offen lds
    s_add_u32 m0, s53, 41984
    s_mov_b32 s48, 332288
    buffer_load_dwordx4 v38, s[12:15], s48 offen lds
    buffer_load_dwordx4 v38, s[12:15], s48 offen offset:1024 lds
    buffer_load_dwordx4 v38, s[12:15], s48 offen offset:2048 lds
    buffer_load_dwordx4 v38, s[12:15], s48 offen offset:3072 lds
    s_lshl_b32 s54, s44, 2
    v_min_u32 v5, 35, v0
    v_lshlrev_b32 v5, 2, v5
    v_mov_b32 v23, 1
    s_cmp_eq_u32 s47, 0
    s_cselect_b64 exec, -1, 0
    buffer_load_dword v23, v5, s[36:39], 0 offen sc1
    s_mov_b64 exec, -1
    s_mul_i32 s55, s44, 3584
    s_add_u32 s55, s55, 5557248
    v_min_u32 v6, 4, v0
    v_lshlrev_b32 v6, 2, v6
    v_mov_b32 v7, 1
    s_waitcnt vmcnt(0)
    s_mov_b32 s49, 0
L_chkz:
    v_cmp_eq_u32 vcc, 0, v23
    s_add_u32 s49, s49, 1
    s_cbranch_vccz L_rdyz
    buffer_load_dword v23, v5, s[36:39], 0 offen sc1
    s_cmp_lt_u32 s49, 0x40000
    s_waitcnt vmcnt(0)
    s_cbranch_scc1 L_chkz
L_rdyz:
    s_barrier
    s_mov_b32 s48, 622080
    s_add_u32 m0, s53, 73728
    s_nop 0
    buffer_load_dwordx4 v38, s[12:15], s48 offen lds
    buffer_load_dwordx4 v38, s[12:15], s48 offen offset:1024 lds
    buffer_load_dwordx4 v38, s[12:15], s48 offen offset:2048 lds
    buffer_load_dwordx4 v38, s[12:15], s48 offen offset:3072 lds
    s_add_u32 m0, s53, 77824
    s_nop 0
    buffer_load_dwordx4 v40, s[12:15], s48 offen lds
    s_add_u32 m0, s53, 78848
    s_mov_b32 s48, 664064
    buffer_load_dwordx4 v38, s[12:15], s48 offen lds
    buffer_load_dwordx4 v38, s[12:15], s48 offen offset:1024 lds
    buffer_load_dwordx4 v38, s[12:15], s48 offen offset:2048 lds
    buffer_load_dwordx4 v38, s[12:15], s48 offen offset:3072 lds
    s_mov_b32 s48, 953856
    s_add_u32 m0, s53, 110592
    s_nop 0
    buffer_load_dwordx4 v38, s[12:15], s48 offen lds
    buffer_load_dwordx4 v38, s[12:15], s48 offen offset:1024 lds
    buffer_load_dwordx4 v38, s[12:15], s48 offen offset:2048 lds
    buffer_load_dwordx4 v38, s[12:15], s48 offen offset:3072 lds
    s_add_u32 m0, s53, 114688
    s_nop 0
    buffer_load_dwordx4 v40, s[12:15], s48 offen lds
    s_add_u32 m0, s53, 115712
    s_mov_b32 s48, 995840
    buffer_load_dwordx4 v38, s[12:15], s48 offen lds
    buffer_load_dwordx4 v38, s[12:15], s48 offen offset:1024 lds
    buffer_load_dwordx4 v38, s[12:15], s48 offen offset:2048 lds
    buffer_load_dwordx4 v38, s[12:15], s48 offen offset:3072 lds
    buffer_load_dword v23, v6, s[40:43], s55 offen offset:3456 sc1
    s_waitcnt vmcnt(10)
    s_barrier
    s_add_u32 m0, s52, 0
    s_mov_b32 s48, 0
    buffer_load_dwordx4 v42, s[20:23], s48 offen lds
    buffer_load_dwordx4 v42, s[20:23], s48 offen offset:1024 lds
    buffer_load_dwordx4 v42, s[20:23], s48 offen offset:2048 lds
    buffer_load_dwordx4 v42, s[20:23], s48 offen offset:3072 lds
    s_add_u32 m0, s52, 4096
    s_mov_b32 s48, 4096
    buffer_load_dwordx4 v42, s[20:23], s48 offen lds
    buffer_load_dwordx4 v42, s[20:23], s48 offen offset:1024 lds
    buffer_load_dwordx4 v42, s[20:23], s48 offen offset:2048 lds
    buffer_load_dwordx4 v42, s[20:23], s48 offen offset:3072 lds
    s_add_u32 m0, s52, 8192
    s_mov_b32 s48, 8192
    buffer_load_dwordx4 v42, s[20:23], s48 offen lds
    buffer_load_dwordx4 v42, s[20:23], s48 offen offset:1024 lds
    s_mov_b64 exec, 0xff
    buffer_load_dwordx4 v42, s[20:23], s48 offen offset:2048 lds
    s_mov_b64 exec, -1
    s_waitcnt vmcnt(11)
    s_mov_b32 s49, 0
L_chkr:
    v_cmp_eq_u32 vcc, 0, v23
    s_add_u32 s49, s49, 1
    s_cbranch_vccz L_rdyr
    buffer_load_dword v23, v6, s[40:43], s55 offen offset:3456 sc1
    s_cmp_lt_u32 s49, 0x40000
    s_waitcnt vmcnt(0)
    s_cbranch_scc1 L_chkr
L_rdyr:
    s_barrier
    s_add_u32 m0, s52, 41472
    s_mov_b32 s48, 6137856
    buffer_load_dwordx4 v42, s[40:43], s48 offen sc1 lds
    buffer_load_dwordx4 v42, s[40:43], s48 offen offset:1024 sc1 lds
    buffer_load_dwordx4 v42, s[40:43], s48 offen offset:2048 sc1 lds
    buffer_load_dwordx4 v42, s[40:43], s48 offen offset:3072 sc1 lds
    s_add_u32 m0, s52, 45568
    s_mov_b32 s48, 6141952
    buffer_load_dwordx4 v42, s[40:43], s48 offen sc1 lds
    buffer_load_dwordx4 v42, s[40:43], s48 offen offset:1024 sc1 lds
    buffer_load_dwordx4 v42, s[40:43], s48 offen offset:2048 sc1 lds
    buffer_load_dwordx4 v42, s[40:43], s48 offen offset:3072 sc1 lds
    s_add_u32 m0, s52, 49664
    s_mov_b32 s48, 6146048
    buffer_load_dwordx4 v42, s[40:43], s48 offen sc1 lds
    buffer_load_dwordx4 v42, s[40:43], s48 offen offset:1024 sc1 lds
    s_mov_b64 exec, 0xff
    buffer_load_dwordx4 v42, s[40:43], s48 offen offset:2048 sc1 lds
    s_mov_b64 exec, -1
    v_readfirstlane_b32 s27, v23
    ds_write_b32 v25, v23
    s_lshl1_add_u32 s24, s44, s27
    s_mul_i32 s24, s24, 9216
    s_cmp_gt_u32 s44, 8
    s_cselect_b32 s25, 128, 0
    s_add_u32 s24, s24, s25
    s_add_u32 s24, s24, 5216256
    s_lshl_b32 s26, s47, 7
    s_lshl1_add_u32 s25, s26, s24
    s_addk_i32 s25, 8192
    s_lshl4_add_u32 s24, s26, s24
    s_lshl3_add_u32 m0, s26, 147456
    s_nop 0
    buffer_load_dwordx4 v24, s[40:43], s24 offen sc1 lds
    s_add_u32 m0, s26, 151552
    s_mov_b64 exec, 0xff
    buffer_load_dwordx4 v24, s[40:43], s25 offen sc1 lds
    s_mov_b64 exec, -1
L_lcommon:
    s_mov_b32 s4, 0x05040100
    s_mov_b32 s5, 0x07060302
    s_cmp_gt_u32 s44, 8
    s_cselect_b32 s52, 2304000, 0
    s_add_u32 s32, s32, s52
    s_addc_u32 s33, s33, 0
    s_movk_i32 s52, 16128
    s_movk_i32 s53, 32256
    s_mov_b32 s54, 48384
    s_mov_b32 s60, 0xbdd2d3e8
    s_mov_b32 s61, s60
    s_waitcnt vmcnt(0)
    s_cmp_gt_u32 s45, 8
    s_cbranch_scc1 L_eh
L_ehd:
    s_mov_b32 s49, 0
    s_mov_b64 exec, s[56:57]
L_poll:
    v_cmp_ne_u32 vcc, 1, v27
    s_add_u32 s49, s49, 1
    s_and_b64 exec, exec, vcc
    s_cbranch_execz L_polld
    buffer_load_dword v27, v22, s[40:43], s55 offen sc1
    s_cmp_lt_u32 s49, 64
    s_waitcnt vmcnt(0)
    s_cbranch_scc1 L_poll
L_polld:
    s_mov_b64 exec, -1
    s_cmp_lg_u32 s47, 0
    s_waitcnt lgkmcnt(0)
    s_barrier
    s_cbranch_scc1 L_shx
L_gatx:
    buffer_load_dwordx4 v[24:27], v10, s[40:43], s16 offen sc1
    buffer_load_dwordx4 v[28:31], v10, s[40:43], s17 offen sc1
    buffer_load_dwordx4 v[32:35], v11, s[40:43], s18 offen sc1
L_shx:
    s_cmp_gt_u32 s45, 8
    s_cbranch_scc1 L_shy
    ds_read_b64 v[238:239], v14 offset:36864
    ds_read_b64 v[240:241], v14 offset:37152
    ds_read_b64 v[242:243], v14 offset:37440
    ds_read_b64 v[244:245], v14 offset:37728
    ds_read_b64 v[246:247], v14 offset:38016
    ds_read_b64 v[248:249], v14 offset:38304
    ds_read_b64 v[250:251], v14 offset:38592
    ds_read_b64 v[252:253], v14 offset:38880
    ds_read_b128 v[94:97], v8 offset:0
    ds_read_b128 v[98:101], v8 offset:288
    ds_read_b128 v[102:105], v8 offset:576
    ds_read_b128 v[106:109], v8 offset:864
    ds_read_b128 v[110:113], v8 offset:1152
    ds_read_b128 v[114:117], v8 offset:1440
    ds_read_b128 v[118:121], v8 offset:1728
    ds_read_b128 v[122:125], v8 offset:2016
    ds_read_b128 v[130:133], v8 offset:9216
    ds_read_b128 v[134:137], v8 offset:9504
    ds_read_b128 v[138:141], v8 offset:9792
    ds_read_b128 v[142:145], v8 offset:10080
    ds_read_b128 v[146:149], v8 offset:10368
    ds_read_b128 v[150:153], v8 offset:10656
    ds_read_b128 v[154:157], v8 offset:10944
    ds_read_b128 v[158:161], v8 offset:11232
    ds_read_b128 v[166:169], v8 offset:18432
    ds_read_b128 v[170:173], v8 offset:18720
    ds_read_b128 v[174:177], v8 offset:19008
    ds_read_b128 v[178:181], v8 offset:19296
    ds_read_b128 v[182:185], v8 offset:19584
    ds_read_b128 v[186:189], v8 offset:19872
    ds_read_b128 v[190:193], v8 offset:20160
    ds_read_b128 v[194:197], v8 offset:20448
    ds_read_b128 v[202:205], v8 offset:27648
    ds_read_b128 v[206:209], v8 offset:27936
    ds_read_b128 v[210:213], v8 offset:28224
    ds_read_b128 v[214:217], v8 offset:28512
    ds_read_b128 v[218:221], v8 offset:28800
    ds_read_b128 v[222:225], v8 offset:29088
    ds_read_b128 v[226:229], v8 offset:29376
    ds_read_b128 v[230:233], v8 offset:29664
    ds_read_b128 v[126:129], v9 offset:0
    ds_read_b128 v[162:165], v9 offset:9216
    ds_read_b128 v[198:201], v9 offset:18432
    ds_read_b128 v[234:237], v9 offset:27648
    ds_read_b64 v[254:255], v15 offset:36864
    ds_read_b128 v[58:61], v18 offset:0
    ds_read_b128 v[62:65], v18 offset:512
    ds_read_b128 v[66:69], v18 offset:1024
    ds_read_b128 v[70:73], v18 offset:1536
    ds_read_b128 v[74:77], v18 offset:2048
    ds_read_b128 v[78:81], v18 offset:2560
    ds_read_b128 v[82:85], v18 offset:3072
    ds_read_b128 v[86:89], v18 offset:3584
    ds_read_b128 v[90:93], v18 offset:4096
    ds_read_b64_tr_b16 v[4:5], v19 offset:256
    ds_read_b64_tr_b16 v[6:7], v19 offset:4864
    ds_read_b64_tr_b16 v[14:15], v19 offset:9472
    ds_read_b64_tr_b16 v[16:17], v19 offset:14080
    ds_read_b64_tr_b16 v[36:37], v19 offset:18688
    ds_read_b64_tr_b16 v[38:39], v19 offset:23296
    ds_read_b64_tr_b16 v[40:41], v19 offset:27904
    ds_read_b64_tr_b16 v[42:43], v19 offset:32512
    ds_read_b64_tr_b16 v[18:19], v19 offset:37120
L_shy:
    s_cmp_lg_u32 s47, 0
    s_cbranch_scc1 L_bf
L_shdx:
    s_waitcnt vmcnt(2)
    v_mfma_f32_16x16x32_bf16 v[44:47], v[52:55], v[24:27], 0
    s_waitcnt vmcnt(1)
    v_mfma_f32_16x16x32_bf16 v[44:47], v[52:55], v[28:31], v[44:47]
    s_waitcnt vmcnt(0)
    v_mfma_f32_16x16x32_bf16 v[44:47], v[52:55], v[32:35], v[44:47]
    s_nop 7
    v_cmp_u_f32 vcc, v44, v44
L_gelux:
    v_pk_mul_f32 v[48:49], v[44:45], v[44:45]
    v_pk_mul_f32 v[50:51], v[46:47], v[46:47]
    v_pk_fma_f32 v[48:49], v[48:49], s[60:61], v[56:57]
    v_pk_fma_f32 v[50:51], v[50:51], s[60:61], v[56:57]
    v_pk_mul_f32 v[48:49], v[48:49], v[44:45]
    v_pk_mul_f32 v[50:51], v[50:51], v[46:47]
    s_cbranch_vccnz L_slowx
    v_exp_f32 v48, v48
    v_exp_f32 v49, v49
    v_exp_f32 v50, v50
    v_exp_f32 v51, v51
    v_pk_add_f32 v[48:49], v[48:49], 1.0 op_sel_hi:[1,0]
    v_pk_add_f32 v[50:51], v[50:51], 1.0 op_sel_hi:[1,0]
    v_rcp_f32 v48, v48
    v_rcp_f32 v49, v49
    v_rcp_f32 v50, v50
    v_rcp_f32 v51, v51
    v_pk_mul_f32 v[44:45], v[44:45], v[48:49]
    v_pk_mul_f32 v[46:47], v[46:47], v[50:51]
    v_cvt_pk_bf16_f32 v44, v44, v45
    v_cvt_pk_bf16_f32 v45, v46, v47
    ds_write_b64 v12, v[44:45]
    s_waitcnt lgkmcnt(0)
L_bf:
    s_barrier
    ds_read_b64 v[22:23], v21
    ds_read_b128 v[24:27], v20 offset:0
    ds_read_b128 v[28:31], v20 offset:512
    ds_read_b128 v[32:35], v20 offset:1024
    ds_read_b128 v[44:47], v20 offset:1536
    s_cmp_eq_u32 s27, 2
    s_waitcnt lgkmcnt(4)
    v_mfma_f32_16x16x16_bf16 v[52:55], v[18:19], v[22:23], 0
    s_waitcnt lgkmcnt(3)
    s_nop 4
    v_mfma_f32_16x16x32_bf16 v[52:55], v[4:7], v[24:27], v[52:55]
    s_waitcnt lgkmcnt(2)
    v_mfma_f32_16x16x32_bf16 v[52:55], v[14:17], v[28:31], v[52:55]
    s_waitcnt lgkmcnt(1)
    v_mfma_f32_16x16x32_bf16 v[52:55], v[36:39], v[32:35], v[52:55]
    s_waitcnt lgkmcnt(0)
    v_mfma_f32_16x16x32_bf16 v[52:55], v[40:43], v[44:47], v[52:55]
    s_nop 7
    v_mul_f32 v52, 0x4038aa3b, v52
    v_mul_f32 v53, 0x4038aa3b, v53
    v_mul_f32 v54, 0x4038aa3b, v54
    v_mul_f32 v55, 0x4038aa3b, v55
    s_cbranch_scc1 L_fb8
L_fb8d:
    v_exp_f32 v52, v52
    v_exp_f32 v53, v53
    v_exp_f32 v54, v54
    v_exp_f32 v55, v55
    v_pk_fma_f32 v[90:91], v[90:91], v[52:53], 1.0 op_sel_hi:[1,1,0]
    v_pk_fma_f32 v[92:93], v[92:93], v[54:55], 1.0 op_sel_hi:[1,1,0]
    v_rcp_f32 v90, v90
    v_rcp_f32 v91, v91
    v_rcp_f32 v92, v92
    v_rcp_f32 v93, v93
    v_pk_fma_f32 v[90:91], v[90:91], -2.0, 1.0 op_sel_hi:[1,0,0]
    v_pk_fma_f32 v[92:93], v[92:93], -2.0, 1.0 op_sel_hi:[1,0,0]
L_pad1:
    s_cbranch_execz L_back
    v_cvt_pk_bf16_f32 v90, v90, v91
    v_cvt_pk_bf16_f32 v91, v92, v93
    s_cmp_eq_u32 s27, 2
    s_barrier
    s_cbranch_scc1 L_fb
L_out:
    ds_read_b128 v[4:7], v2 offset:0
    ds_read_b128 v[8:11], v2 offset:512
    ds_read_b128 v[12:15], v2 offset:1024
    ds_read_b128 v[16:19], v2 offset:1536
    v_mfma_f32_16x16x16_bf16 v[52:55], v[254:255], v[90:91], 0
    v_mfma_f32_16x16x16_bf16 v[20:23], v[90:91], v[238:239], 0
    v_mfma_f32_16x16x16_bf16 v[24:27], v[90:91], v[240:241], 0
    s_waitcnt lgkmcnt(2)
    v_pk_fma_f32 v[58:59], v[58:59], v[4:5], 1.0 op_sel_hi:[1,1,0]
    v_pk_fma_f32 v[60:61], v[60:61], v[6:7], 1.0 op_sel_hi:[1,1,0]
    v_pk_fma_f32 v[62:63], v[62:63], v[8:9], 1.0 op_sel_hi:[1,1,0]
    v_pk_fma_f32 v[64:65], v[64:65], v[10:11], 1.0 op_sel_hi:[1,1,0]
    ds_read_b128 v[4:7], v2 offset:2048
    ds_read_b128 v[8:11], v2 offset:2560
    v_mfma_f32_16x16x16_bf16 v[28:31], v[90:91], v[242:243], 0
    v_rcp_f32 v58, v58
    v_mfma_f32_16x16x16_bf16 v[32:35], v[90:91], v[244:245], 0
    v_rcp_f32 v59, v59
    v_mfma_f32_16x16x16_bf16 v[36:39], v[90:91], v[246:247], 0
    v_rcp_f32 v60, v60
    v_mfma_f32_16x16x16_bf16 v[40:43], v[90:91], v[248:249], 0
    v_rcp_f32 v61, v61
    v_mfma_f32_16x16x16_bf16 v[44:47], v[90:91], v[250:251], 0
    v_rcp_f32 v62, v62
    v_mfma_f32_16x16x16_bf16 v[48:51], v[90:91], v[252:253], 0
    v_rcp_f32 v63, v63
    v_rcp_f32 v64, v64
    v_rcp_f32 v65, v65
    v_pk_fma_f32 v[58:59], v[58:59], -2.0, 1.0 op_sel_hi:[1,0,0]
    v_pk_fma_f32 v[60:61], v[60:61], -2.0, 1.0 op_sel_hi:[1,0,0]
    v_pk_fma_f32 v[62:63], v[62:63], -2.0, 1.0 op_sel_hi:[1,0,0]
    v_pk_fma_f32 v[64:65], v[64:65], -2.0, 1.0 op_sel_hi:[1,0,0]
    v_cvt_pk_bf16_f32 v58, v58, v59
    v_cvt_pk_bf16_f32 v59, v60, v61
    v_cvt_pk_bf16_f32 v60, v62, v63
    v_cvt_pk_bf16_f32 v61, v64, v65
    s_waitcnt lgkmcnt(2)
    v_pk_fma_f32 v[66:67], v[66:67], v[12:13], 1.0 op_sel_hi:[1,1,0]
    v_pk_fma_f32 v[68:69], v[68:69], v[14:15], 1.0 op_sel_hi:[1,1,0]
    v_pk_fma_f32 v[70:71], v[70:71], v[16:17], 1.0 op_sel_hi:[1,1,0]
    v_pk_fma_f32 v[72:73], v[72:73], v[18:19], 1.0 op_sel_hi:[1,1,0]
    ds_read_b128 v[12:15], v2 offset:3072
    ds_read_b128 v[16:19], v2 offset:3584
    v_mfma_f32_16x16x32_bf16 v[52:55], v[126:129], v[58:61], v[52:55]
    v_rcp_f32 v66, v66
    v_mfma_f32_16x16x32_bf16 v[20:23], v[58:61], v[94:97], v[20:23]
    v_rcp_f32 v67, v67
    v_mfma_f32_16x16x32_bf16 v[24:27], v[58:61], v[98:101], v[24:27]
    v_rcp_f32 v68, v68
    v_mfma_f32_16x16x32_bf16 v[28:31], v[58:61], v[102:105], v[28:31]
    v_rcp_f32 v69, v69
    v_mfma_f32_16x16x32_bf16 v[32:35], v[58:61], v[106:109], v[32:35]
    v_rcp_f32 v70, v70
    v_mfma_f32_16x16x32_bf16 v[36:39], v[58:61], v[110:113], v[36:39]
    v_rcp_f32 v71, v71
    v_mfma_f32_16x16x32_bf16 v[40:43], v[58:61], v[114:117], v[40:43]
    v_rcp_f32 v72, v72
    v_mfma_f32_16x16x32_bf16 v[44:47], v[58:61], v[118:121], v[44:47]
    v_rcp_f32 v73, v73
    v_mfma_f32_16x16x32_bf16 v[48:51], v[58:61], v[122:125], v[48:51]
    v_fma_f32 v66, v66, -2.0, 1.0
    v_fma_f32 v67, v67, -2.0, 1.0
    v_fma_f32 v68, v68, -2.0, 1.0
    v_fma_f32 v69, v69, -2.0, 1.0
    v_pk_fma_f32 v[70:71], v[70:71], -2.0, 1.0 op_sel_hi:[1,0,0]
    v_pk_fma_f32 v[72:73], v[72:73], -2.0, 1.0 op_sel_hi:[1,0,0]
    v_cvt_pk_bf16_f32 v66, v66, v67
    v_cvt_pk_bf16_f32 v67, v68, v69
    v_cvt_pk_bf16_f32 v68, v70, v71
    v_cvt_pk_bf16_f32 v69, v72, v73
    s_waitcnt lgkmcnt(2)
    v_pk_fma_f32 v[74:75], v[74:75], v[4:5], 1.0 op_sel_hi:[1,1,0]
    v_pk_fma_f32 v[76:77], v[76:77], v[6:7], 1.0 op_sel_hi:[1,1,0]
    v_pk_fma_f32 v[78:79], v[78:79], v[8:9], 1.0 op_sel_hi:[1,1,0]
    v_pk_fma_f32 v[80:81], v[80:81], v[10:11], 1.0 op_sel_hi:[1,1,0]
    v_mfma_f32_16x16x32_bf16 v[52:55], v[162:165], v[66:69], v[52:55]
    v_rcp_f32 v74, v74
    v_mfma_f32_16x16x32_bf16 v[20:23], v[66:69], v[130:133], v[20:23]
    v_rcp_f32 v75, v75
    v_mfma_f32_16x16x32_bf16 v[24:27], v[66:69], v[134:137], v[24:27]
    v_rcp_f32 v76, v76
    v_mfma_f32_16x16x32_bf16 v[28:31], v[66:69], v[138:141], v[28:31]
    v_rcp_f32 v77, v77
    v_mfma_f32_16x16x32_bf16 v[32:35], v[66:69], v[142:145], v[32:35]
    v_rcp_f32 v78, v78
    v_mfma_f32_16x16x32_bf16 v[36:39], v[66:69], v[146:149], v[36:39]
    v_rcp_f32 v79, v79
    v_mfma_f32_16x16x32_bf16 v[40:43], v[66:69], v[150:153], v[40:43]
    v_rcp_f32 v80, v80
    v_mfma_f32_16x16x32_bf16 v[44:47], v[66:69], v[154:157], v[44:47]
    v_rcp_f32 v81, v81
    v_mfma_f32_16x16x32_bf16 v[48:51], v[66:69], v[158:161], v[48:51]
    v_fma_f32 v74, v74, -2.0, 1.0
    v_fma_f32 v75, v75, -2.0, 1.0
    v_fma_f32 v76, v76, -2.0, 1.0
    v_fma_f32 v77, v77, -2.0, 1.0
    v_pk_fma_f32 v[78:79], v[78:79], -2.0, 1.0 op_sel_hi:[1,0,0]
    v_pk_fma_f32 v[80:81], v[80:81], -2.0, 1.0 op_sel_hi:[1,0,0]
    v_cvt_pk_bf16_f32 v74, v74, v75
    v_cvt_pk_bf16_f32 v75, v76, v77
    v_cvt_pk_bf16_f32 v76, v78, v79
    v_cvt_pk_bf16_f32 v77, v80, v81
    s_waitcnt lgkmcnt(0)
    v_pk_fma_f32 v[82:83], v[82:83], v[12:13], 1.0 op_sel_hi:[1,1,0]
    v_pk_fma_f32 v[84:85], v[84:85], v[14:15], 1.0 op_sel_hi:[1,1,0]
    v_pk_fma_f32 v[86:87], v[86:87], v[16:17], 1.0 op_sel_hi:[1,1,0]
    v_pk_fma_f32 v[88:89], v[88:89], v[18:19], 1.0 op_sel_hi:[1,1,0]
    v_mfma_f32_16x16x32_bf16 v[52:55], v[198:201], v[74:77], v[52:55]
    v_rcp_f32 v82, v82
    v_mfma_f32_16x16x32_bf16 v[20:23], v[74:77], v[166:169], v[20:23]
    v_rcp_f32 v83, v83
    v_mfma_f32_16x16x32_bf16 v[24:27], v[74:77], v[170:173], v[24:27]
    v_rcp_f32 v84, v84
    v_mfma_f32_16x16x32_bf16 v[28:31], v[74:77], v[174:177], v[28:31]
    v_rcp_f32 v85, v85
    v_mfma_f32_16x16x32_bf16 v[32:35], v[74:77], v[178:181], v[32:35]
    v_rcp_f32 v86, v86
    v_mfma_f32_16x16x32_bf16 v[36:39], v[74:77], v[182:185], v[36:39]
    v_rcp_f32 v87, v87
    v_mfma_f32_16x16x32_bf16 v[40:43], v[74:77], v[186:189], v[40:43]
    v_rcp_f32 v88, v88
    v_mfma_f32_16x16x32_bf16 v[44:47], v[74:77], v[190:193], v[44:47]
    v_rcp_f32 v89, v89
    v_mfma_f32_16x16x32_bf16 v[48:51], v[74:77], v[194:197], v[48:51]
    v_fma_f32 v82, v82, -2.0, 1.0
    v_fma_f32 v83, v83, -2.0, 1.0
    v_fma_f32 v84, v84, -2.0, 1.0
    v_fma_f32 v85, v85, -2.0, 1.0
    v_pk_fma_f32 v[86:87], v[86:87], -2.0, 1.0 op_sel_hi:[1,0,0]
    v_pk_fma_f32 v[88:89], v[88:89], -2.0, 1.0 op_sel_hi:[1,0,0]
    v_cvt_pk_bf16_f32 v82, v82, v83
    v_cvt_pk_bf16_f32 v83, v84, v85
    v_cvt_pk_bf16_f32 v84, v86, v87
    v_cvt_pk_bf16_f32 v85, v88, v89
    s_nop 1
    v_mfma_f32_16x16x32_bf16 v[52:55], v[234:237], v[82:85], v[52:55]
    s_nop 2
    v_mfma_f32_16x16x32_bf16 v[20:23], v[82:85], v[202:205], v[20:23]
    s_nop 2
    v_mfma_f32_16x16x32_bf16 v[24:27], v[82:85], v[206:209], v[24:27]
    v_cvt_pk_bf16_f32 v58, v52, v53
    v_cvt_pk_bf16_f32 v59, v54, v55
    v_mfma_f32_16x16x32_bf16 v[28:31], v[82:85], v[210:213], v[28:31]
    buffer_store_dwordx2 v[58:59], v3, s[32:35], 0 offen offset:256 nt
    s_nop 1
    v_mfma_f32_16x16x32_bf16 v[32:35], v[82:85], v[214:217], v[32:35]
    s_nop 0
    v_cvt_pk_bf16_f32 v4, v20, v24
    v_cvt_pk_bf16_f32 v8, v21, v25
    v_mfma_f32_16x16x32_bf16 v[36:39], v[82:85], v[218:221], v[36:39]
    v_cvt_pk_bf16_f32 v12, v22, v26
    v_cvt_pk_bf16_f32 v16, v23, v27
L_pad2:
    s_cbranch_execz L_back
    s_nop 0
    v_mfma_f32_16x16x32_bf16 v[40:43], v[82:85], v[222:225], v[40:43]
    v_cvt_pk_bf16_f32 v5, v28, v32
    v_cvt_pk_bf16_f32 v9, v29, v33
    s_nop 0
    v_mfma_f32_16x16x32_bf16 v[44:47], v[82:85], v[226:229], v[44:47]
    v_cvt_pk_bf16_f32 v13, v30, v34
    v_cvt_pk_bf16_f32 v17, v31, v35
    s_nop 0
    v_mfma_f32_16x16x32_bf16 v[48:51], v[82:85], v[230:233], v[48:51]
    v_cvt_pk_bf16_f32 v6, v36, v40
    v_cvt_pk_bf16_f32 v10, v37, v41
    v_cvt_pk_bf16_f32 v14, v38, v42
    v_cvt_pk_bf16_f32 v18, v39, v43
    s_nop 3
    v_cvt_pk_bf16_f32 v7, v44, v48
    buffer_store_dwordx4 v[4:7], v1, s[32:35], 0 offen nt
    v_cvt_pk_bf16_f32 v11, v45, v49
    buffer_store_dwordx4 v[8:11], v1, s[32:35], s52 offen nt
    v_cvt_pk_bf16_f32 v15, v46, v50
    buffer_store_dwordx4 v[12:15], v1, s[32:35], s53 offen nt
    v_cvt_pk_bf16_f32 v19, v47, v51
    buffer_store_dwordx4 v[16:19], v1, s[32:35], s54 offen nt
    s_endpgm
L_cw:
    s_load_dwordx2 s[16:17], s[0:1], 24
    s_mov_b32 s18, 4608
    s_mov_b32 s19, s7
    s_load_dwordx2 s[36:37], s[0:1], 64
    s_mov_b32 s38, 256
    s_mov_b32 s39, s7
    s_load_dwordx2 s[40:41], s[0:1], 72
    s_mov_b32 s42, 6179328
    s_mov_b32 s43, s7
    v_and_b32 v172, 15, v0
    v_lshrrev_b32 v173, 4, v0
    v_lshrrev_b32 v174, 2, v0
    v_mul_u32_u24 v174, 288, v174
    v_and_b32 v2, 3, v0
    v_lshl_add_u32 v174, v2, 3, v174
    s_lshl_b32 s48, s47, 6
    v_add_u32 v175, s48, v174
    s_mul_i32 s49, s44, 14
    s_add_u32 s48, s49, s45
    s_mul_i32 s48, s48, 20736
    s_lshl_b32 s50, s47, 9
    s_add_u32 s20, s48, s50
    s_add_u32 s21, s20, 4608
    s_add_u32 s22, s20, 9216
    s_add_u32 s23, s20, 13824
    s_add_u32 s24, s20, 18432
    s_mul_i32 s49, s49, 9
    s_add_u32 s49, s49, s45
    s_mul_i32 s49, s49, 2304
    s_add_u32 s25, s49, s50
    s_mul_i32 s26, s47, 82944
    s_add_u32 s26, s26, s49
    s_mov_b32 s63, 0
    v_bfrev_b32 v7, 1
    v_and_b32 v2, 31, v0
    v_lshlrev_b32 v2, 4, v2
    v_lshrrev_b32 v3, 5, v0
    v_cmp_gt_u32 vcc, 32, v0
    v_mul_u32_u24 v4, 2304, v3
    v_add_u32 v242, v4, v2
    v_cndmask_b32 v243, v7, v2, vcc
    v_and_b32 v4, 1, v173
    v_lshl_add_u32 v2, v3, 4, v172
    v_lshl_add_u32 v2, v2, 1, v4
    s_add_u32 s50, s50, 126976
    v_lshl_add_u32 v248, v2, 3, s50
    v_lshlrev_b32 v253, 3, v2
    v_lshrrev_b32 v5, 3, v172
    v_lshl_add_u32 v3, v3, 1, v5
    v_mul_u32_u24 v3, 20736, v3
    v_mul_u32_u24 v5, 20736, v5
    v_and_b32 v2, 7, v0
    v_lshl_add_u32 v6, v4, 3, v2
    v_lshl_add_u32 v3, v6, 4, v3
    s_cmp_eq_u32 s47, 3
    s_cselect_b32 vcc_hi, 0, -1
    v_lshl_add_u32 v2, v173, 3, v2
    v_cndmask_b32 v241, v7, v3, vcc
    v_lshl_add_u32 v240, v2, 4, v5
    s_mov_b32 s48, 126976
    v_lshl_add_u32 v249, v2, 4, s48
    s_addk_i32 s48, 2048
    v_lshl_add_u32 v250, v2, 3, s48
    v_and_b32 v3, 8, v0
    v_add_u32 v3, 4096, v3
    v_add_u32 v252, v3, v249
    s_lshl_b32 s48, s47, 10
    v_mul_u32_u24 v3, 448, v4
    v_add3_u32 v251, s48, v3, v252
    v_lshlrev_b32 v3, 6, v173
    v_sub_u32 v251, v251, v3
    v_lshlrev_b32 v4, 3, v4
    v_sub_u32 v2, v172, v4
    v_and_b32 v247, 1, v2
    v_lshlrev_b32 v247, 4, v247
    s_movk_i32 s48, 0x3f80
    v_lshlrev_b32 v247, v247, s48
    v_lshrrev_b32 v2, 1, v2
    v_cmp_eq_u32 vcc, 0, v2
    s_nop 1
    v_cndmask_b32 v244, 0, v247, vcc
    v_cmp_eq_u32 vcc, 1, v2
    s_nop 1
    v_cndmask_b32 v245, 0, v247, vcc
    v_cmp_eq_u32 vcc, 2, v2
    s_nop 1
    v_cndmask_b32 v246, 0, v247, vcc
    v_cmp_eq_u32 vcc, 3, v2
    s_nop 1
    v_cndmask_b32 v247, 0, v247, vcc
    s_cmp_eq_u32 s47, 3
    s_cselect_b64 vcc, 1, 0
    v_cndmask_b32 v254, v7, 0, vcc
    s_mul_i32 s48, s44, 3584
    s_lshl_b32 s28, s45, 7
    s_add_u32 s48, s48, s28
    s_add_u32 s28, s48, 5557248
    s_mov_b32 s60, 0xbdd2d3e8
    s_mov_b32 s61, s60
    v_mov_b32 v220, 0xc0135761
    v_mov_b32 v221, v220
    s_cmp_gt_u32 s45, 8
    s_cbranch_scc1 L_chelp
    v_lshlrev_b32 v15, 3, v0
    v_add_u32 v2, 4, v172
    v_lshrrev_b32 v2, 2, v2
    v_and_b32 v2, 2, v2
    v_xor_b32 v2, s47, v2
    v_mul_u32_u24 v10, 1056, v172
    v_lshl_add_u32 v10, v173, 4, v10
    v_lshl_add_u32 v10, v2, 8, v10
    v_add_u32 v3, 1, v2
    v_and_b32 v3, 4, v3
    v_lshl_add_u32 v11, v3, 3, v10
    v_add_u32 v3, 2, v2
    v_and_b32 v3, 4, v3
    v_lshl_add_u32 v12, v3, 3, v10
    v_add_u32 v3, 3, v2
    v_and_b32 v3, 4, v3
    v_lshl_add_u32 v13, v3, 3, v10
    v_lshlrev_b32 v216, 11, v173
    v_add_u32 v216, 155648, v216
    v_lshl_add_u32 v215, v172, 7, v216
    v_lshl_add_u32 v215, v2, 5, v215
    s_lshl_b32 s48, s47, 5
    v_mul_u32_u24 v217, 112, v172
    v_add_u32 v216, v217, v216
    v_add_u32 v217, s48, v216
    v_mov_b32 v222, v175
    v_mov_b32 v223, v174
    v_add_u32 v212, 64512, v175
    v_add_u32 v213, 64512, v174
    s_mul_i32 s48, s44, 14
    s_sub_u32 s48, s48, 1
    v_add_u32 v3, s48, v172
    s_movk_i32 s49, 251
    s_movk_i32 s50, 125
    v_cmp_gt_u32 vcc, s49, v3
    v_cmp_ne_u32 s[56:57], s50, v3
    v_mov_b32 v218, 0x7f800000
    s_and_b64 vcc, vcc, s[56:57]
    v_cndmask_b32 v218, v218, 1.0, vcc
    v_mov_b32 v219, v218
    s_mov_b32 s65, 16800
    s_mov_b32 s74, 34688
    s_mov_b32 s83, 86976
    s_mov_b32 s66, 69024
    s_mov_b32 s75, 34752
    s_mov_b32 s84, 121312
    s_mov_b32 s67, 69088
    s_mov_b32 s76, 103360
    s_mov_b32 s85, 52640
    s_mov_b32 s68, 16736
    s_mov_b32 s77, 103424
    s_mov_b32 s86, 86976
    s_mov_b32 s69, 16800
    s_mov_b32 s78, 34688
    s_mov_b32 s87, 121312
    s_mov_b32 s70, 69024
    s_mov_b32 s79, 34752
    s_mov_b32 s88, 52640
    s_mov_b32 s71, 69088
    s_mov_b32 s80, 103360
    s_mov_b32 s89, 86976
    s_mov_b32 s72, 137696
    s_mov_b32 s81, 103424
    s_mov_b32 s90, 121312
    v_add_u32 v2, 16736, v10
    v_add_u32 v6, 137760, v10
    v_add_u32 v3, 16736, v11
    v_add_u32 v7, 137760, v11
    v_add_u32 v4, 16736, v12
    v_add_u32 v8, 137760, v12
    v_add_u32 v5, 16736, v13
    v_add_u32 v9, 137760, v13
    v_add_u32 v14, 52640, v15
    v_mov_b32 v16, 0
    v_mov_b32 v17, 0
    v_mov_b32 v18, 0
    v_mov_b32 v19, 0
    v_mov_b32 v20, 0
    v_mov_b32 v21, 0
    v_mov_b32 v22, 0
    v_mov_b32 v23, 0
    v_mov_b32 v24, 0
    v_mov_b32 v25, 0
    v_mov_b32 v26, 0
    v_mov_b32 v27, 0
    v_mov_b32 v28, 0
    v_mov_b32 v29, 0
    v_mov_b32 v30, 0
    v_mov_b32 v31, 0
    s_mov_b32 s62, 0
    s_waitcnt lgkmcnt(0)
L_walk:
    s_mov_b64 exec, 0
    s_cmp_lt_u32 s47, 1
    s_cbranch_scc1 L_pad0
    s_cmp_lt_u32 s47, 2
    s_cbranch_scc1 L_pad3
    s_cmp_lt_u32 s47, 3
    s_cbranch_scc1 L_pad1
    s_branch L_pad2
L_back:
    s_mov_b64 exec, -1
    s_cmp_gt_u32 s45, 8
    s_cbranch_scc1 L_cbw
    s_waitcnt vmcnt(0)
    s_barrier
    ds_read_b128 v[96:99], v2 offset:0
    ds_read_b128 v[100:103], v6 offset:0
    ds_read_b128 v[104:107], v2 offset:128
    ds_read_b64_tr_b16 v[32:33], v14 offset:0
    ds_read_b64_tr_b16 v[34:35], v14 offset:512
    ds_read_b128 v[108:111], v6 offset:128
    ds_read_b64_tr_b16 v[36:37], v14 offset:1024
    ds_read_b64_tr_b16 v[38:39], v14 offset:1536
    ds_read_b128 v[112:115], v3 offset:256
    ds_read_b64_tr_b16 v[40:41], v14 offset:2048
    ds_read_b64_tr_b16 v[42:43], v14 offset:2560
    ds_read_b128 v[116:119], v7 offset:256
    ds_read_b64_tr_b16 v[44:45], v14 offset:3072
    ds_read_b64_tr_b16 v[46:47], v14 offset:3584
    ds_read_b128 v[120:123], v3 offset:384
L_c1:
    s_waitcnt lgkmcnt(9)
    v_mfma_f32_16x16x32_bf16 v[16:19], v[32:35], v[96:99], v[16:19]
    ds_read_b64_tr_b16 v[48:49], v14 offset:4096
    v_mfma_f32_16x16x32_bf16 v[20:23], v[32:35], v[100:103], v[20:23]
    ds_read_b64_tr_b16 v[50:51], v14 offset:4608
    v_mfma_f32_16x16x32_bf16 v[24:27], v[32:35], v[104:107], v[24:27]
    ds_read_b128 v[124:127], v7 offset:384
    v_mfma_f32_16x16x32_bf16 v[28:31], v[32:35], v[108:111], v[28:31]
    s_waitcnt lgkmcnt(9)
    v_mfma_f32_16x16x32_bf16 v[16:19], v[36:39], v[100:103], v[16:19]
    ds_read_b64_tr_b16 v[52:53], v14 offset:5120
    v_mfma_f32_16x16x32_bf16 v[20:23], v[36:39], v[104:107], v[20:23]
    ds_read_b64_tr_b16 v[54:55], v14 offset:5632
    v_mfma_f32_16x16x32_bf16 v[24:27], v[36:39], v[108:111], v[24:27]
    ds_read_b128 v[128:131], v4 offset:512
    v_mfma_f32_16x16x32_bf16 v[28:31], v[36:39], v[112:115], v[28:31]
    s_waitcnt lgkmcnt(9)
    v_mfma_f32_16x16x32_bf16 v[16:19], v[40:43], v[104:107], v[16:19]
    ds_read_b64_tr_b16 v[56:57], v14 offset:6144
    v_mfma_f32_16x16x32_bf16 v[20:23], v[40:43], v[108:111], v[20:23]
    ds_read_b64_tr_b16 v[58:59], v14 offset:6656
    v_mfma_f32_16x16x32_bf16 v[24:27], v[40:43], v[112:115], v[24:27]
    ds_read_b128 v[132:135], v8 offset:512
    v_mfma_f32_16x16x32_bf16 v[28:31], v[40:43], v[116:119], v[28:31]
    s_waitcnt lgkmcnt(9)
    v_mfma_f32_16x16x32_bf16 v[16:19], v[44:47], v[108:111], v[16:19]
    ds_read_b64_tr_b16 v[60:61], v14 offset:7168
    v_mfma_f32_16x16x32_bf16 v[20:23], v[44:47], v[112:115], v[20:23]
    ds_read_b64_tr_b16 v[62:63], v14 offset:7680
    v_mfma_f32_16x16x32_bf16 v[24:27], v[44:47], v[116:119], v[24:27]
    ds_read_b128 v[136:139], v4 offset:640
    v_mfma_f32_16x16x32_bf16 v[28:31], v[44:47], v[120:123], v[28:31]
    s_waitcnt lgkmcnt(9)
    v_mfma_f32_16x16x32_bf16 v[16:19], v[48:51], v[112:115], v[16:19]
    ds_read_b64_tr_b16 v[64:65], v14 offset:8192
    v_mfma_f32_16x16x32_bf16 v[20:23], v[48:51], v[116:119], v[20:23]
    ds_read_b64_tr_b16 v[66:67], v14 offset:8704
    v_mfma_f32_16x16x32_bf16 v[24:27], v[48:51], v[120:123], v[24:27]
    ds_read_b128 v[140:143], v8 offset:640
    v_mfma_f32_16x16x32_bf16 v[28:31], v[48:51], v[124:127], v[28:31]
    s_waitcnt lgkmcnt(9)
    v_mfma_f32_16x16x32_bf16 v[16:19], v[52:55], v[116:119], v[16:19]
    ds_read_b64_tr_b16 v[68:69], v14 offset:9216
    v_mfma_f32_16x16x32_bf16 v[20:23], v[52:55], v[120:123], v[20:23]
    ds_read_b64_tr_b16 v[70:71], v14 offset:9728
    v_mfma_f32_16x16x32_bf16 v[24:27], v[52:55], v[124:127], v[24:27]
    ds_read_b128 v[144:147], v5 offset:768
    v_mfma_f32_16x16x32_bf16 v[28:31], v[52:55], v[128:131], v[28:31]
    s_waitcnt lgkmcnt(9)
    v_mfma_f32_16x16x32_bf16 v[16:19], v[56:59], v[120:123], v[16:19]
    ds_read_b64_tr_b16 v[72:73], v14 offset:10240
    v_mfma_f32_16x16x32_bf16 v[20:23], v[56:59], v[124:127], v[20:23]
    ds_read_b64_tr_b16 v[74:75], v14 offset:10752
    v_mfma_f32_16x16x32_bf16 v[24:27], v[56:59], v[128:131], v[24:27]
    ds_read_b128 v[148:151], v9 offset:768
    v_mfma_f32_16x16x32_bf16 v[28:31], v[56:59], v[132:135], v[28:31]
    s_waitcnt lgkmcnt(9)
    v_mfma_f32_16x16x32_bf16 v[16:19], v[60:63], v[124:127], v[16:19]
    ds_read_b64_tr_b16 v[76:77], v14 offset:11264
    v_mfma_f32_16x16x32_bf16 v[20:23], v[60:63], v[128:131], v[20:23]
    ds_read_b64_tr_b16 v[78:79], v14 offset:11776
    v_mfma_f32_16x16x32_bf16 v[24:27], v[60:63], v[132:135], v[24:27]
    ds_read_b128 v[152:155], v5 offset:896
    v_mfma_f32_16x16x32_bf16 v[28:31], v[60:63], v[136:139], v[28:31]
    s_waitcnt lgkmcnt(9)
    v_mfma_f32_16x16x32_bf16 v[16:19], v[64:67], v[128:131], v[16:19]
    ds_read_b64_tr_b16 v[80:81], v14 offset:12288
    v_mfma_f32_16x16x32_bf16 v[20:23], v[64:67], v[132:135], v[20:23]
    ds_read_b64_tr_b16 v[82:83], v14 offset:12800
    v_mfma_f32_16x16x32_bf16 v[24:27], v[64:67], v[136:139], v[24:27]
    ds_read_b128 v[156:159], v9 offset:896
    v_mfma_f32_16x16x32_bf16 v[28:31], v[64:67], v[140:143], v[28:31]
    s_waitcnt lgkmcnt(9)
    v_mfma_f32_16x16x32_bf16 v[16:19], v[68:71], v[132:135], v[16:19]
    ds_read_b64_tr_b16 v[84:85], v14 offset:13312
    v_mfma_f32_16x16x32_bf16 v[20:23], v[68:71], v[136:139], v[20:23]
    ds_read_b64_tr_b16 v[86:87], v14 offset:13824
    v_mfma_f32_16x16x32_bf16 v[24:27], v[68:71], v[140:143], v[24:27]
    ds_read_b128 v[160:163], v2 offset:1056
    v_mfma_f32_16x16x32_bf16 v[28:31], v[68:71], v[144:147], v[28:31]
    s_waitcnt lgkmcnt(9)
    v_mfma_f32_16x16x32_bf16 v[16:19], v[72:75], v[136:139], v[16:19]
    ds_read_b64_tr_b16 v[88:89], v14 offset:14336
    ds_read_b64_tr_b16 v[90:91], v14 offset:14848
    v_mfma_f32_16x16x32_bf16 v[20:23], v[72:75], v[140:143], v[20:23]
    ds_read_b128 v[164:167], v6 offset:1056
    v_mfma_f32_16x16x32_bf16 v[24:27], v[72:75], v[144:147], v[24:27]
    s_add_u32 s62, s62, 1
    v_mfma_f32_16x16x32_bf16 v[28:31], v[72:75], v[148:151], v[28:31]
    s_min_u32 m0, s62, 8
    s_waitcnt lgkmcnt(9)
    v_mfma_f32_16x16x32_bf16 v[16:19], v[76:79], v[140:143], v[16:19]
    ds_read_b64_tr_b16 v[92:93], v14 offset:15360
    ds_read_b64_tr_b16 v[94:95], v14 offset:15872
    v_mfma_f32_16x16x32_bf16 v[20:23], v[76:79], v[144:147], v[20:23]
    ds_read_b128 v[168:171], v2 offset:1184
    v_mfma_f32_16x16x32_bf16 v[24:27], v[76:79], v[148:151], v[24:27]
    s_movrels_b32 s52, s64
    s_movrels_b32 s53, s73
    v_mfma_f32_16x16x32_bf16 v[28:31], v[76:79], v[152:155], v[28:31]
    s_movrels_b32 s54, s82
    s_waitcnt lgkmcnt(9)
    v_mfma_f32_16x16x32_bf16 v[16:19], v[80:83], v[144:147], v[16:19]
    v_add_u32 v14, s54, v15
    v_add_u32 v2, s52, v10
    v_add_u32 v6, s53, v10
    v_mfma_f32_16x16x32_bf16 v[20:23], v[80:83], v[148:151], v[20:23]
    v_add_u32 v3, s52, v11
    v_add_u32 v7, s53, v11
    v_mfma_f32_16x16x32_bf16 v[24:27], v[80:83], v[152:155], v[24:27]
    v_add_u32 v4, s52, v12
    v_add_u32 v8, s53, v12
    v_mfma_f32_16x16x32_bf16 v[28:31], v[80:83], v[156:159], v[28:31]
    v_add_u32 v5, s52, v13
    v_add_u32 v9, s53, v13
    s_cmp_eq_u32 s62, 8
    s_waitcnt lgkmcnt(0)
    s_barrier
    v_mfma_f32_16x16x32_bf16 v[16:19], v[84:87], v[148:151], v[16:19]
    ds_read_b128 v[96:99], v2 offset:0
    ds_read_b128 v[100:103], v6 offset:0
    v_mfma_f32_16x16x32_bf16 v[20:23], v[84:87], v[152:155], v[20:23]
    ds_read_b128 v[104:107], v2 offset:128
    ds_read_b64_tr_b16 v[32:33], v14 offset:0
    v_mfma_f32_16x16x32_bf16 v[24:27], v[84:87], v[156:159], v[24:27]
    ds_read_b64_tr_b16 v[34:35], v14 offset:512
    ds_read_b128 v[108:111], v6 offset:128
    v_mfma_f32_16x16x32_bf16 v[28:31], v[84:87], v[160:163], v[28:31]
    ds_read_b64_tr_b16 v[36:37], v14 offset:1024
    ds_read_b64_tr_b16 v[38:39], v14 offset:1536
    v_mfma_f32_16x16x32_bf16 v[16:19], v[88:91], v[152:155], v[16:19]
    ds_read_b128 v[112:115], v3 offset:256
    ds_read_b64_tr_b16 v[40:41], v14 offset:2048
    v_mfma_f32_16x16x32_bf16 v[20:23], v[88:91], v[156:159], v[20:23]
    ds_read_b64_tr_b16 v[42:43], v14 offset:2560
    ds_read_b128 v[116:119], v7 offset:256
    v_mfma_f32_16x16x32_bf16 v[24:27], v[88:91], v[160:163], v[24:27]
    ds_read_b64_tr_b16 v[44:45], v14 offset:3072
    ds_read_b64_tr_b16 v[46:47], v14 offset:3584
    v_mfma_f32_16x16x32_bf16 v[28:31], v[88:91], v[164:167], v[28:31]
    ds_read_b128 v[120:123], v3 offset:384
    s_cbranch_scc1 L_c1tail
    s_cmp_gt_u32 s62, 5
    s_cbranch_scc1 L_c1
    v_mfma_f32_16x16x32_bf16 v[16:19], v[92:95], v[156:159], v[16:19]
    v_mfma_f32_16x16x32_bf16 v[20:23], v[92:95], v[160:163], v[20:23]
    v_mfma_f32_16x16x32_bf16 v[24:27], v[92:95], v[164:167], v[24:27]
    v_mfma_f32_16x16x32_bf16 v[28:31], v[92:95], v[168:171], v[28:31]
    s_branch L_c1
L_c1tail:
    s_waitcnt lgkmcnt(10)
    v_mfma_f32_16x16x32_bf16 v[16:19], v[32:35], v[96:99], v[16:19]
    ds_read_b64_tr_b16 v[48:49], v14 offset:4096
    ds_read_b64_tr_b16 v[50:51], v14 offset:4608
    s_waitcnt lgkmcnt(9)
    v_mfma_f32_16x16x32_bf16 v[16:19], v[36:39], v[100:103], v[16:19]
    ds_read_b64_tr_b16 v[52:53], v14 offset:5120
    ds_read_b64_tr_b16 v[54:55], v14 offset:5632
    v_mfma_f32_16x16x32_bf16 v[20:23], v[32:35], v[100:103], v[20:23]
    ds_read_b64_tr_b16 v[56:57], v14 offset:6144
    ds_read_b64_tr_b16 v[58:59], v14 offset:6656
    s_waitcnt lgkmcnt(10)
    v_mfma_f32_16x16x32_bf16 v[16:19], v[40:43], v[104:107], v[16:19]
    ds_read_b64_tr_b16 v[60:61], v14 offset:7168
    ds_read_b64_tr_b16 v[62:63], v14 offset:7680
    s_waitcnt lgkmcnt(9)
    v_mfma_f32_16x16x32_bf16 v[16:19], v[44:47], v[108:111], v[16:19]
    ds_read_b128 v[124:127], v7 offset:384
    ds_read_b64_tr_b16 v[64:65], v14 offset:8192
    v_mfma_f32_16x16x32_bf16 v[20:23], v[36:39], v[104:107], v[20:23]
    ds_read_b64_tr_b16 v[66:67], v14 offset:8704
    ds_read_b128 v[128:131], v4 offset:512
    s_waitcnt lgkmcnt(10)
    v_mfma_f32_16x16x32_bf16 v[16:19], v[48:51], v[112:115], v[16:19]
    ds_read_b64_tr_b16 v[68:69], v14 offset:9216
    ds_read_b64_tr_b16 v[70:71], v14 offset:9728
    s_waitcnt lgkmcnt(10)
    v_mfma_f32_16x16x32_bf16 v[16:19], v[52:55], v[116:119], v[16:19]
    ds_read_b128 v[132:135], v8 offset:512
    ds_read_b64_tr_b16 v[72:73], v14 offset:10240
    v_mfma_f32_16x16x32_bf16 v[20:23], v[40:43], v[108:111], v[20:23]
    ds_read_b64_tr_b16 v[74:75], v14 offset:10752
    ds_read_b128 v[136:139], v4 offset:640
    s_waitcnt lgkmcnt(12)
    v_mfma_f32_16x16x32_bf16 v[16:19], v[56:59], v[120:123], v[16:19]
    ds_read_b64_tr_b16 v[76:77], v14 offset:11264
    ds_read_b64_tr_b16 v[78:79], v14 offset:11776
    s_waitcnt lgkmcnt(11)
    v_mfma_f32_16x16x32_bf16 v[16:19], v[60:63], v[124:127], v[16:19]
    ds_read_b128 v[140:143], v8 offset:640
    ds_read_b64_tr_b16 v[80:81], v14 offset:12288
    s_waitcnt lgkmcnt(10)
    v_mfma_f32_16x16x32_bf16 v[16:19], v[64:67], v[128:131], v[16:19]
    ds_read_b64_tr_b16 v[82:83], v14 offset:12800
    ds_read_b128 v[144:147], v5 offset:768
    v_mfma_f32_16x16x32_bf16 v[20:23], v[44:47], v[112:115], v[20:23]
    ds_read_b64_tr_b16 v[84:85], v14 offset:13312
    ds_read_b64_tr_b16 v[86:87], v14 offset:13824
    s_waitcnt lgkmcnt(11)
    v_mfma_f32_16x16x32_bf16 v[16:19], v[68:71], v[132:135], v[16:19]
    ds_read_b128 v[148:151], v9 offset:768
    ds_read_b64_tr_b16 v[88:89], v14 offset:14336
    s_waitcnt lgkmcnt(10)
    v_mfma_f32_16x16x32_bf16 v[16:19], v[72:75], v[136:139], v[16:19]
    ds_read_b64_tr_b16 v[90:91], v14 offset:14848
    ds_read_b128 v[152:155], v5 offset:896
    v_mfma_f32_16x16x32_bf16 v[20:23], v[48:51], v[116:119], v[20:23]
    ds_read_b128 v[156:159], v9 offset:896
    ds_read_b128 v[160:163], v2 offset:1056
    s_waitcnt lgkmcnt(11)
    v_mfma_f32_16x16x32_bf16 v[16:19], v[76:79], v[140:143], v[16:19]
    ds_read_b128 v[164:167], v6 offset:1056
    s_waitcnt lgkmcnt(9)
    v_mfma_f32_16x16x32_bf16 v[16:19], v[80:83], v[144:147], v[16:19]
    v_mfma_f32_16x16x32_bf16 v[20:23], v[52:55], v[120:123], v[20:23]
    s_waitcnt lgkmcnt(6)
    v_mfma_f32_16x16x32_bf16 v[16:19], v[84:87], v[148:151], v[16:19]
    s_waitcnt lgkmcnt(3)
    v_mfma_f32_16x16x32_bf16 v[16:19], v[88:91], v[152:155], v[16:19]
    s_nop 2
    v_mfma_f32_16x16x32_bf16 v[20:23], v[56:59], v[124:127], v[20:23]
    s_nop 2
    v_mfma_f32_16x16x32_bf16 v[20:23], v[60:63], v[128:131], v[20:23]
    v_mul_f32 v224, v16, v16
    v_mul_f32 v225, v17, v17
    v_mfma_f32_16x16x32_bf16 v[20:23], v[64:67], v[132:135], v[20:23]
    v_mul_f32 v226, v18, v18
    v_mul_f32 v227, v19, v19
    v_mfma_f32_16x16x32_bf16 v[24:27], v[32:35], v[104:107], v[24:27]
    v_fma_f32 v224, v224, s60, v220
    v_fma_f32 v225, v225, s60, v220
    v_mfma_f32_16x16x32_bf16 v[20:23], v[68:71], v[136:139], v[20:23]
    v_fma_f32 v226, v226, s60, v220
    v_fma_f32 v227, v227, s60, v220
    v_mfma_f32_16x16x32_bf16 v[28:31], v[32:35], v[108:111], v[28:31]
    v_mul_f32 v224, v224, v16
    v_mul_f32 v225, v225, v17
    v_mfma_f32_16x16x32_bf16 v[20:23], v[72:75], v[140:143], v[20:23]
    v_mul_f32 v226, v226, v18
    v_mul_f32 v227, v227, v19
    v_mfma_f32_16x16x32_bf16 v[24:27], v[36:39], v[108:111], v[24:27]
    v_exp_f32 v224, v224
    v_mfma_f32_16x16x32_bf16 v[28:31], v[36:39], v[112:115], v[28:31]
    v_exp_f32 v225, v225
    v_mfma_f32_16x16x32_bf16 v[20:23], v[76:79], v[144:147], v[20:23]
    v_exp_f32 v226, v226
    v_mfma_f32_16x16x32_bf16 v[24:27], v[40:43], v[112:115], v[24:27]
    v_exp_f32 v227, v227
    v_mfma_f32_16x16x32_bf16 v[28:31], v[40:43], v[116:119], v[28:31]
    v_add_f32 v224, v224, v218
    v_add_f32 v225, v225, v218
    v_mfma_f32_16x16x32_bf16 v[20:23], v[80:83], v[148:151], v[20:23]
    v_add_f32 v226, v226, v218
    v_add_f32 v227, v227, v218
    v_mfma_f32_16x16x32_bf16 v[24:27], v[44:47], v[116:119], v[24:27]
    v_rcp_f32 v224, v224
    v_mfma_f32_16x16x32_bf16 v[20:23], v[84:87], v[152:155], v[20:23]
    v_rcp_f32 v225, v225
    v_mfma_f32_16x16x32_bf16 v[28:31], v[44:47], v[120:123], v[28:31]
    v_rcp_f32 v226, v226
    v_mfma_f32_16x16x32_bf16 v[24:27], v[48:51], v[120:123], v[24:27]
    v_rcp_f32 v227, v227
    s_waitcnt lgkmcnt(2)
    v_mfma_f32_16x16x32_bf16 v[20:23], v[88:91], v[156:159], v[20:23]
    v_mul_f32 v16, v16, v224
    v_mul_f32 v17, v17, v225
    v_mfma_f32_16x16x32_bf16 v[28:31], v[48:51], v[124:127], v[28:31]
    v_mul_f32 v18, v18, v226
    v_mul_f32 v19, v19, v227
    v_mfma_f32_16x16x32_bf16 v[24:27], v[52:55], v[124:127], v[24:27]
    v_cvt_pk_bf16_f32 v232, v16, v17
    v_cvt_pk_bf16_f32 v233, v18, v19
    v_mfma_f32_16x16x32_bf16 v[28:31], v[52:55], v[128:131], v[28:31]
    v_mul_f32 v228, v20, v20
    v_mul_f32 v229, v21, v21
    v_mfma_f32_16x16x32_bf16 v[24:27], v[56:59], v[128:131], v[24:27]
    v_mul_f32 v230, v22, v22
    v_mul_f32 v231, v23, v23
    v_mfma_f32_16x16x32_bf16 v[28:31], v[56:59], v[132:135], v[28:31]
    v_fma_f32 v228, v228, s60, v220
    v_fma_f32 v229, v229, s60, v220
    v_mfma_f32_16x16x32_bf16 v[24:27], v[60:63], v[132:135], v[24:27]
    v_fma_f32 v230, v230, s60, v220
    v_fma_f32 v231, v231, s60, v220
    v_mfma_f32_16x16x32_bf16 v[28:31], v[60:63], v[136:139], v[28:31]
    v_mul_f32 v228, v228, v20
    v_mul_f32 v229, v229, v21
    v_mfma_f32_16x16x32_bf16 v[24:27], v[64:67], v[136:139], v[24:27]
    v_mul_f32 v230, v230, v22
    v_mul_f32 v231, v231, v23
    v_mfma_f32_16x16x32_bf16 v[28:31], v[64:67], v[140:143], v[28:31]
    v_exp_f32 v228, v228
    v_mfma_f32_16x16x32_bf16 v[24:27], v[68:71], v[140:143], v[24:27]
    v_exp_f32 v229, v229
    v_mfma_f32_16x16x32_bf16 v[28:31], v[68:71], v[144:147], v[28:31]
    v_exp_f32 v230, v230
    v_mfma_f32_16x16x32_bf16 v[24:27], v[72:75], v[144:147], v[24:27]
    v_exp_f32 v231, v231
    v_mfma_f32_16x16x32_bf16 v[28:31], v[72:75], v[148:151], v[28:31]
    v_add_f32 v228, v228, v218
    v_add_f32 v229, v229, v218
    v_mfma_f32_16x16x32_bf16 v[24:27], v[76:79], v[148:151], v[24:27]
    v_add_f32 v230, v230, v218
    v_add_f32 v231, v231, v218
    v_mfma_f32_16x16x32_bf16 v[28:31], v[76:79], v[152:155], v[28:31]
    v_rcp_f32 v228, v228
    v_mfma_f32_16x16x32_bf16 v[24:27], v[80:83], v[152:155], v[24:27]
    v_rcp_f32 v229, v229
    v_mfma_f32_16x16x32_bf16 v[28:31], v[80:83], v[156:159], v[28:31]
    v_rcp_f32 v230, v230
    v_mfma_f32_16x16x32_bf16 v[24:27], v[84:87], v[156:159], v[24:27]
    v_rcp_f32 v231, v231
    s_waitcnt lgkmcnt(1)
    v_mfma_f32_16x16x32_bf16 v[28:31], v[84:87], v[160:163], v[28:31]
    v_mul_f32 v20, v20, v228
    v_mul_f32 v21, v21, v229
    v_mfma_f32_16x16x32_bf16 v[24:27], v[88:91], v[160:163], v[24:27]
    v_mul_f32 v22, v22, v230
    v_mul_f32 v23, v23, v231
    s_waitcnt lgkmcnt(0)
    v_mfma_f32_16x16x32_bf16 v[28:31], v[88:91], v[164:167], v[28:31]
    v_cvt_pk_bf16_f32 v234, v20, v21
    v_cvt_pk_bf16_f32 v235, v22, v23
    ds_write_b128 v215, v[232:235] offset:0
    s_nop 0
    v_mul_f32 v224, v24, v24
    v_mul_f32 v225, v25, v25
    v_pk_mul_f32 v[226:227], v[26:27], v[26:27]
    v_pk_fma_f32 v[224:225], v[224:225], s[60:61], v[220:221]
    v_pk_fma_f32 v[226:227], v[226:227], s[60:61], v[220:221]
    v_pk_mul_f32 v[224:225], v[224:225], v[24:25]
    v_pk_mul_f32 v[226:227], v[226:227], v[26:27]
    v_exp_f32 v224, v224
    v_exp_f32 v225, v225
    v_exp_f32 v226, v226
    v_exp_f32 v227, v227
    v_pk_add_f32 v[224:225], v[224:225], v[218:219]
    v_pk_add_f32 v[226:227], v[226:227], v[218:219]
    v_rcp_f32 v224, v224
    v_rcp_f32 v225, v225
    v_rcp_f32 v226, v226
    v_rcp_f32 v227, v227
    v_pk_mul_f32 v[24:25], v[24:25], v[224:225]
    v_pk_mul_f32 v[26:27], v[26:27], v[226:227]
    v_cvt_pk_bf16_f32 v236, v24, v25
    v_cvt_pk_bf16_f32 v237, v26, v27
    v_pk_mul_f32 v[228:229], v[28:29], v[28:29]
    v_pk_mul_f32 v[230:231], v[30:31], v[30:31]
    v_pk_fma_f32 v[228:229], v[228:229], s[60:61], v[220:221]
    v_pk_fma_f32 v[230:231], v[230:231], s[60:61], v[220:221]
    v_pk_mul_f32 v[228:229], v[228:229], v[28:29]
    v_pk_mul_f32 v[230:231], v[230:231], v[30:31]
    v_exp_f32 v228, v228
    v_exp_f32 v229, v229
    v_exp_f32 v230, v230
    v_exp_f32 v231, v231
    v_pk_add_f32 v[228:229], v[228:229], v[218:219]
    v_pk_add_f32 v[230:231], v[230:231], v[218:219]
    v_rcp_f32 v228, v228
    v_rcp_f32 v229, v229
    v_rcp_f32 v230, v230
    v_rcp_f32 v231, v231
    v_pk_mul_f32 v[28:29], v[28:29], v[228:229]
    v_pk_mul_f32 v[30:31], v[30:31], v[230:231]
    v_cvt_pk_bf16_f32 v238, v28, v29
    v_cvt_pk_bf16_f32 v239, v30, v31
    ds_write_b128 v215, v[236:239] offset:16
    s_waitcnt lgkmcnt(0)
    s_barrier
    ds_read_b64_tr_b16 v[4:5], v175 offset:0
    ds_read_b64_tr_b16 v[6:7], v175 offset:4608
    ds_read_b128 v[8:11], v216 offset:0
    ds_read_b64_tr_b16 v[12:13], v175 offset:32
    ds_read_b64_tr_b16 v[14:15], v175 offset:4640
    ds_read_b128 v[16:19], v216 offset:16
    ds_read_b128 v[20:23], v216 offset:32
    ds_read_b128 v[24:27], v216 offset:48
    ds_read_b128 v[28:31], v216 offset:64
    ds_read_b128 v[96:99], v216 offset:80
    s_waitcnt lgkmcnt(5)
    v_mfma_f32_16x16x32_bf16 v[32:35], v[4:7], v[8:11], 0
    ds_read_b128 v[100:103], v216 offset:96
    v_mfma_f32_16x16x32_bf16 v[36:39], v[12:15], v[8:11], 0
    ds_read_b64_tr_b16 v[104:105], v174 offset:256
    s_waitcnt lgkmcnt(6)
    v_mfma_f32_16x16x32_bf16 v[40:43], v[4:7], v[16:19], 0
    ds_read_b64_tr_b16 v[106:107], v174 offset:4864
    v_mfma_f32_16x16x32_bf16 v[44:47], v[12:15], v[16:19], 0
    ds_read_b128 v[108:111], v217 offset:0
    s_waitcnt lgkmcnt(7)
    v_mfma_f32_16x16x32_bf16 v[48:51], v[4:7], v[20:23], 0
    ds_read_b128 v[112:115], v217 offset:16
    v_mfma_f32_16x16x32_bf16 v[52:55], v[12:15], v[20:23], 0
    ds_read_b64_tr_b16 v[116:117], v175 offset:9216
    s_waitcnt lgkmcnt(8)
    v_mfma_f32_16x16x32_bf16 v[56:59], v[4:7], v[24:27], 0
    ds_read_b64_tr_b16 v[118:119], v175 offset:13824
    v_mfma_f32_16x16x32_bf16 v[60:63], v[12:15], v[24:27], 0
    ds_read_b64_tr_b16 v[120:121], v175 offset:9248
    s_waitcnt lgkmcnt(9)
    v_mfma_f32_16x16x32_bf16 v[64:67], v[4:7], v[28:31], 0
    ds_read_b64_tr_b16 v[122:123], v175 offset:13856
    v_mfma_f32_16x16x32_bf16 v[68:71], v[12:15], v[28:31], 0
    s_waitcnt lgkmcnt(9)
    v_mfma_f32_16x16x32_bf16 v[72:75], v[4:7], v[96:99], 0
    v_mfma_f32_16x16x32_bf16 v[76:79], v[12:15], v[96:99], 0
    s_waitcnt lgkmcnt(8)
    v_mfma_f32_16x16x32_bf16 v[80:83], v[4:7], v[100:103], 0
    v_mfma_f32_16x16x32_bf16 v[84:87], v[12:15], v[100:103], 0
    s_waitcnt lgkmcnt(4)
    v_mfma_f32_16x16x32_bf16 v[88:91], v[104:107], v[108:111], 0
    v_mfma_f32_16x16x32_bf16 v[92:95], v[104:107], v[112:115], 0
    ds_read_b128 v[124:127], v216 offset:112
    s_waitcnt lgkmcnt(1)
    v_mfma_f32_16x16x32_bf16 v[32:35], v[116:119], v[16:19], v[32:35]
    ds_read_b64_tr_b16 v[128:129], v174 offset:9472
    v_mfma_f32_16x16x32_bf16 v[36:39], v[120:123], v[16:19], v[36:39]
    ds_read_b64_tr_b16 v[130:131], v174 offset:14080
    v_mfma_f32_16x16x32_bf16 v[40:43], v[116:119], v[20:23], v[40:43]
    ds_read_b128 v[132:135], v217 offset:32
    v_mfma_f32_16x16x32_bf16 v[44:47], v[120:123], v[20:23], v[44:47]
    ds_read_b64_tr_b16 v[136:137], v175 offset:18432
    v_mfma_f32_16x16x32_bf16 v[48:51], v[116:119], v[24:27], v[48:51]
    v_add_u32 v222, 129024, v175
    v_add_u32 v223, 129024, v174
    v_mfma_f32_16x16x32_bf16 v[52:55], v[120:123], v[24:27], v[52:55]
    v_mov_b32 v1, 1
    v_mfma_f32_16x16x32_bf16 v[56:59], v[116:119], v[28:31], v[56:59]
    ds_read_b64_tr_b16 v[138:139], v175 offset:23040
    v_mfma_f32_16x16x32_bf16 v[60:63], v[120:123], v[28:31], v[60:63]
    ds_read_b64_tr_b16 v[140:141], v175 offset:18464
    v_mfma_f32_16x16x32_bf16 v[64:67], v[116:119], v[96:99], v[64:67]
    ds_read_b64_tr_b16 v[142:143], v175 offset:23072
    v_mfma_f32_16x16x32_bf16 v[68:71], v[120:123], v[96:99], v[68:71]
    v_mfma_f32_16x16x32_bf16 v[72:75], v[116:119], v[100:103], v[72:75]
    v_mfma_f32_16x16x32_bf16 v[76:79], v[120:123], v[100:103], v[76:79]
    s_waitcnt lgkmcnt(7)
    v_mfma_f32_16x16x32_bf16 v[80:83], v[116:119], v[124:127], v[80:83]
    v_mfma_f32_16x16x32_bf16 v[84:87], v[120:123], v[124:127], v[84:87]
    s_waitcnt lgkmcnt(4)
    v_mfma_f32_16x16x32_bf16 v[88:91], v[128:131], v[112:115], v[88:91]
    v_mfma_f32_16x16x32_bf16 v[92:95], v[128:131], v[132:135], v[92:95]
    s_waitcnt lgkmcnt(0)
    v_mfma_f32_16x16x32_bf16 v[32:35], v[136:139], v[20:23], v[32:35]
    v_mfma_f32_16x16x32_bf16 v[36:39], v[140:143], v[20:23], v[36:39]
    ds_read_b128 v[144:147], v216 offset:128
    v_mfma_f32_16x16x32_bf16 v[40:43], v[136:139], v[24:27], v[40:43]
    ds_read_b64_tr_b16 v[148:149], v174 offset:18688
    v_mfma_f32_16x16x32_bf16 v[44:47], v[140:143], v[24:27], v[44:47]
    ds_read_b64_tr_b16 v[150:151], v174 offset:23296
    v_mfma_f32_16x16x32_bf16 v[48:51], v[136:139], v[28:31], v[48:51]
    ds_read_b128 v[152:155], v217 offset:48
    v_mfma_f32_16x16x32_bf16 v[52:55], v[140:143], v[28:31], v[52:55]
    ds_read_b64_tr_b16 v[156:157], v175 offset:27648
    v_mfma_f32_16x16x32_bf16 v[56:59], v[136:139], v[96:99], v[56:59]
    ds_read_b64_tr_b16 v[158:159], v175 offset:32256
    v_mfma_f32_16x16x32_bf16 v[60:63], v[140:143], v[96:99], v[60:63]
    ds_read_b64_tr_b16 v[160:161], v175 offset:27680
    v_mfma_f32_16x16x32_bf16 v[64:67], v[136:139], v[100:103], v[64:67]
    ds_read_b64_tr_b16 v[162:163], v175 offset:32288
    v_mfma_f32_16x16x32_bf16 v[68:71], v[140:143], v[100:103], v[68:71]
    v_mfma_f32_16x16x32_bf16 v[72:75], v[136:139], v[124:127], v[72:75]
    v_mfma_f32_16x16x32_bf16 v[76:79], v[140:143], v[124:127], v[76:79]
    s_waitcnt lgkmcnt(7)
    v_mfma_f32_16x16x32_bf16 v[80:83], v[136:139], v[144:147], v[80:83]
    v_mfma_f32_16x16x32_bf16 v[84:87], v[140:143], v[144:147], v[84:87]
    s_waitcnt lgkmcnt(4)
    v_mfma_f32_16x16x32_bf16 v[88:91], v[148:151], v[132:135], v[88:91]
    v_mfma_f32_16x16x32_bf16 v[92:95], v[148:151], v[152:155], v[92:95]
    s_waitcnt lgkmcnt(0)
    v_mfma_f32_16x16x32_bf16 v[32:35], v[156:159], v[24:27], v[32:35]
    v_mfma_f32_16x16x32_bf16 v[36:39], v[160:163], v[24:27], v[36:39]
    ds_read_b128 v[164:167], v216 offset:144
    v_mfma_f32_16x16x32_bf16 v[40:43], v[156:159], v[28:31], v[40:43]
    ds_read_b64_tr_b16 v[168:169], v174 offset:27904
    v_mfma_f32_16x16x32_bf16 v[44:47], v[160:163], v[28:31], v[44:47]
    ds_read_b64_tr_b16 v[170:171], v174 offset:32512
    v_mfma_f32_16x16x32_bf16 v[48:51], v[156:159], v[96:99], v[48:51]
    ds_read_b128 v[176:179], v217 offset:64
    v_mfma_f32_16x16x32_bf16 v[52:55], v[160:163], v[96:99], v[52:55]
    ds_read_b64_tr_b16 v[180:181], v175 offset:36864
    v_mfma_f32_16x16x32_bf16 v[56:59], v[156:159], v[100:103], v[56:59]
    ds_read_b64_tr_b16 v[182:183], v175 offset:41472
    v_mfma_f32_16x16x32_bf16 v[60:63], v[160:163], v[100:103], v[60:63]
    ds_read_b64_tr_b16 v[184:185], v175 offset:36896
    v_mfma_f32_16x16x32_bf16 v[64:67], v[156:159], v[124:127], v[64:67]
    ds_read_b64_tr_b16 v[186:187], v175 offset:41504
    v_mfma_f32_16x16x32_bf16 v[68:71], v[160:163], v[124:127], v[68:71]
    v_mfma_f32_16x16x32_bf16 v[72:75], v[156:159], v[144:147], v[72:75]
    v_mfma_f32_16x16x32_bf16 v[76:79], v[160:163], v[144:147], v[76:79]
    s_waitcnt lgkmcnt(7)
    v_mfma_f32_16x16x32_bf16 v[80:83], v[156:159], v[164:167], v[80:83]
    v_mfma_f32_16x16x32_bf16 v[84:87], v[160:163], v[164:167], v[84:87]
    s_waitcnt lgkmcnt(4)
    v_mfma_f32_16x16x32_bf16 v[88:91], v[168:171], v[152:155], v[88:91]
    v_mfma_f32_16x16x32_bf16 v[92:95], v[168:171], v[176:179], v[92:95]
    s_waitcnt lgkmcnt(0)
    v_mfma_f32_16x16x32_bf16 v[32:35], v[180:183], v[28:31], v[32:35]
    v_mfma_f32_16x16x32_bf16 v[36:39], v[184:187], v[28:31], v[36:39]
    ds_read_b128 v[188:191], v216 offset:160
    v_mfma_f32_16x16x32_bf16 v[40:43], v[180:183], v[96:99], v[40:43]
    ds_read_b64_tr_b16 v[192:193], v174 offset:37120
    v_mfma_f32_16x16x32_bf16 v[44:47], v[184:187], v[96:99], v[44:47]
    ds_read_b64_tr_b16 v[194:195], v174 offset:41728
    v_mfma_f32_16x16x32_bf16 v[48:51], v[180:183], v[100:103], v[48:51]
    ds_read_b128 v[196:199], v217 offset:80
    v_mfma_f32_16x16x32_bf16 v[52:55], v[184:187], v[100:103], v[52:55]
    ds_read_b64_tr_b16 v[200:201], v175 offset:46080
    v_mfma_f32_16x16x32_bf16 v[56:59], v[180:183], v[124:127], v[56:59]
    ds_read_b64_tr_b16 v[202:203], v175 offset:50688
    v_mfma_f32_16x16x32_bf16 v[60:63], v[184:187], v[124:127], v[60:63]
    ds_read_b64_tr_b16 v[204:205], v175 offset:46112
    v_mfma_f32_16x16x32_bf16 v[64:67], v[180:183], v[144:147], v[64:67]
    ds_read_b64_tr_b16 v[206:207], v175 offset:50720
    v_mfma_f32_16x16x32_bf16 v[68:71], v[184:187], v[144:147], v[68:71]
    v_mfma_f32_16x16x32_bf16 v[72:75], v[180:183], v[164:167], v[72:75]
    v_mfma_f32_16x16x32_bf16 v[76:79], v[184:187], v[164:167], v[76:79]
    s_waitcnt lgkmcnt(7)
    v_mfma_f32_16x16x32_bf16 v[80:83], v[180:183], v[188:191], v[80:83]
    v_mfma_f32_16x16x32_bf16 v[84:87], v[184:187], v[188:191], v[84:87]
    s_waitcnt lgkmcnt(4)
L_pad3:
    s_cbranch_execz L_back
    v_mfma_f32_16x16x32_bf16 v[88:91], v[192:195], v[176:179], v[88:91]
    v_mfma_f32_16x16x32_bf16 v[92:95], v[192:195], v[196:199], v[92:95]
    s_barrier
    s_waitcnt lgkmcnt(0)
    v_mfma_f32_16x16x32_bf16 v[32:35], v[200:203], v[96:99], v[32:35]
    v_mfma_f32_16x16x32_bf16 v[36:39], v[204:207], v[96:99], v[36:39]
    ds_read_b128 v[208:211], v216 offset:176
    v_mfma_f32_16x16x32_bf16 v[40:43], v[200:203], v[100:103], v[40:43]
    ds_read_b64_tr_b16 v[224:225], v174 offset:46336
    v_mfma_f32_16x16x32_bf16 v[44:47], v[204:207], v[100:103], v[44:47]
    ds_read_b64_tr_b16 v[226:227], v174 offset:50944
    v_mfma_f32_16x16x32_bf16 v[48:51], v[200:203], v[124:127], v[48:51]
    ds_read_b128 v[228:231], v217 offset:96
    v_mfma_f32_16x16x32_bf16 v[52:55], v[204:207], v[124:127], v[52:55]
    ds_read_b64_tr_b16 v[232:233], v175 offset:55296
    v_mfma_f32_16x16x32_bf16 v[56:59], v[200:203], v[144:147], v[56:59]
    ds_read_b64_tr_b16 v[234:235], v175 offset:59904
    v_mfma_f32_16x16x32_bf16 v[60:63], v[204:207], v[144:147], v[60:63]
    ds_read_b64_tr_b16 v[236:237], v175 offset:55328
    v_mfma_f32_16x16x32_bf16 v[64:67], v[200:203], v[164:167], v[64:67]
    ds_read_b64_tr_b16 v[238:239], v175 offset:59936
    v_mfma_f32_16x16x32_bf16 v[68:71], v[204:207], v[164:167], v[68:71]
    v_mfma_f32_16x16x32_bf16 v[72:75], v[200:203], v[188:191], v[72:75]
    v_mfma_f32_16x16x32_bf16 v[76:79], v[204:207], v[188:191], v[76:79]
    s_waitcnt lgkmcnt(7)
    v_mfma_f32_16x16x32_bf16 v[80:83], v[200:203], v[208:211], v[80:83]
    v_mfma_f32_16x16x32_bf16 v[84:87], v[204:207], v[208:211], v[84:87]
    s_waitcnt lgkmcnt(4)
    v_mfma_f32_16x16x32_bf16 v[88:91], v[224:227], v[196:199], v[88:91]
    v_mfma_f32_16x16x32_bf16 v[92:95], v[224:227], v[228:231], v[92:95]
    s_waitcnt lgkmcnt(0)
    v_mfma_f32_16x16x32_bf16 v[32:35], v[232:235], v[100:103], v[32:35]
    ds_read_b128 v[8:11], v216 offset:192
    v_mfma_f32_16x16x32_bf16 v[36:39], v[236:239], v[100:103], v[36:39]
    ds_read_b64_tr_b16 v[4:5], v174 offset:55552
    v_mfma_f32_16x16x32_bf16 v[40:43], v[232:235], v[124:127], v[40:43]
    ds_read_b64_tr_b16 v[6:7], v174 offset:60160
    v_mfma_f32_16x16x32_bf16 v[44:47], v[236:239], v[124:127], v[44:47]
    ds_read_b128 v[12:15], v217 offset:112
    v_mfma_f32_16x16x32_bf16 v[48:51], v[232:235], v[144:147], v[48:51]
    ds_read_b64_tr_b16 v[108:109], v212 offset:0
    v_mfma_f32_16x16x32_bf16 v[52:55], v[236:239], v[144:147], v[52:55]
    ds_read_b64_tr_b16 v[110:111], v212 offset:4608
    v_mfma_f32_16x16x32_bf16 v[56:59], v[232:235], v[164:167], v[56:59]
    ds_read_b64_tr_b16 v[104:105], v212 offset:32
    v_mfma_f32_16x16x32_bf16 v[60:63], v[236:239], v[164:167], v[60:63]
    ds_read_b64_tr_b16 v[106:107], v212 offset:4640
    v_mfma_f32_16x16x32_bf16 v[64:67], v[232:235], v[188:191], v[64:67]
    ds_read_b128 v[16:19], v216 offset:208
    v_mfma_f32_16x16x32_bf16 v[68:71], v[236:239], v[188:191], v[68:71]
    ds_read_b64_tr_b16 v[116:117], v213 offset:256
    v_mfma_f32_16x16x32_bf16 v[72:75], v[232:235], v[208:211], v[72:75]
    ds_read_b64_tr_b16 v[118:119], v213 offset:4864
    v_mfma_f32_16x16x32_bf16 v[76:79], v[236:239], v[208:211], v[76:79]
    ds_read_b128 v[120:123], v217 offset:128
    s_waitcnt lgkmcnt(11)
    v_mfma_f32_16x16x32_bf16 v[80:83], v[232:235], v[8:11], v[80:83]
    ds_read_b64_tr_b16 v[112:113], v213 offset:9472
    v_mfma_f32_16x16x32_bf16 v[84:87], v[236:239], v[8:11], v[84:87]
    ds_read_b64_tr_b16 v[114:115], v213 offset:14080
    s_waitcnt lgkmcnt(10)
    v_mfma_f32_16x16x32_bf16 v[88:91], v[4:7], v[228:231], v[88:91]
    ds_read_b128 v[128:131], v217 offset:144
    v_mfma_f32_16x16x32_bf16 v[92:95], v[4:7], v[12:15], v[92:95]
    ds_read_b64_tr_b16 v[20:21], v212 offset:9216
    s_waitcnt lgkmcnt(8)
    v_mfma_f32_16x16x32_bf16 v[32:35], v[108:111], v[124:127], v[32:35]
    ds_read_b64_tr_b16 v[22:23], v212 offset:13824
    v_mfma_f32_16x16x32_bf16 v[36:39], v[104:107], v[124:127], v[36:39]
    ds_read_b64_tr_b16 v[136:137], v212 offset:9248
    v_mfma_f32_16x16x32_bf16 v[40:43], v[108:111], v[144:147], v[40:43]
    ds_read_b64_tr_b16 v[138:139], v212 offset:13856
    v_mfma_f32_16x16x32_bf16 v[44:47], v[104:107], v[144:147], v[44:47]
    ds_read_b64_tr_b16 v[140:141], v213 offset:18688
    v_mfma_f32_16x16x32_bf16 v[48:51], v[108:111], v[164:167], v[48:51]
    ds_read_b64_tr_b16 v[142:143], v213 offset:23296
    v_mfma_f32_16x16x32_bf16 v[52:55], v[104:107], v[164:167], v[52:55]
    ds_read_b128 v[132:135], v217 offset:160
    v_mfma_f32_16x16x32_bf16 v[56:59], v[108:111], v[188:191], v[56:59]
    ds_read_b64_tr_b16 v[148:149], v212 offset:18432
    v_mfma_f32_16x16x32_bf16 v[60:63], v[104:107], v[188:191], v[60:63]
    ds_read_b64_tr_b16 v[150:151], v212 offset:23040
    v_mfma_f32_16x16x32_bf16 v[64:67], v[108:111], v[208:211], v[64:67]
    ds_read_b64_tr_b16 v[24:25], v212 offset:18464
    v_mfma_f32_16x16x32_bf16 v[68:71], v[104:107], v[208:211], v[68:71]
    ds_read_b64_tr_b16 v[26:27], v212 offset:23072
    v_mfma_f32_16x16x32_bf16 v[72:75], v[108:111], v[8:11], v[72:75]
    ds_read_b64_tr_b16 v[156:157], v213 offset:27904
    v_mfma_f32_16x16x32_bf16 v[76:79], v[104:107], v[8:11], v[76:79]
    ds_read_b64_tr_b16 v[158:159], v213 offset:32512
    s_waitcnt lgkmcnt(15)
    v_mfma_f32_16x16x32_bf16 v[80:83], v[108:111], v[16:19], v[80:83]
    ds_read_b128 v[160:163], v217 offset:176
    v_mfma_f32_16x16x32_bf16 v[84:87], v[104:107], v[16:19], v[84:87]
    ds_read_b64_tr_b16 v[152:153], v212 offset:27648
    v_mfma_f32_16x16x32_bf16 v[88:91], v[116:119], v[12:15], v[88:91]
    ds_read_b64_tr_b16 v[154:155], v212 offset:32256
    v_mfma_f32_16x16x32_bf16 v[92:95], v[116:119], v[120:123], v[92:95]
    ds_read_b64_tr_b16 v[168:169], v212 offset:27680
    s_waitcnt lgkmcnt(15)
    v_mfma_f32_16x16x32_bf16 v[88:91], v[112:115], v[120:123], v[88:91]
    ds_read_b64_tr_b16 v[170:171], v212 offset:32288
    v_mfma_f32_16x16x32_bf16 v[92:95], v[112:115], v[128:131], v[92:95]
    ds_read_b64_tr_b16 v[28:29], v213 offset:37120
    s_waitcnt lgkmcnt(15)
    v_mfma_f32_16x16x32_bf16 v[32:35], v[20:23], v[144:147], v[32:35]
    ds_read_b64_tr_b16 v[30:31], v213 offset:41728
    v_mfma_f32_16x16x32_bf16 v[36:39], v[136:139], v[144:147], v[36:39]
    s_barrier
    ds_read_b128 v[180:183], v217 offset:192
    v_mfma_f32_16x16x32_bf16 v[40:43], v[20:23], v[164:167], v[40:43]
    ds_read_b64_tr_b16 v[184:185], v212 offset:36864
    v_mfma_f32_16x16x32_bf16 v[44:47], v[136:139], v[164:167], v[44:47]
    ds_read_b64_tr_b16 v[186:187], v212 offset:41472
    v_mfma_f32_16x16x32_bf16 v[48:51], v[20:23], v[188:191], v[48:51]
    ds_read_b64_tr_b16 v[176:177], v212 offset:36896
    v_mfma_f32_16x16x32_bf16 v[52:55], v[136:139], v[188:191], v[52:55]
    ds_read_b64_tr_b16 v[178:179], v212 offset:41504
    s_waitcnt lgkmcnt(15)
    v_mfma_f32_16x16x32_bf16 v[88:91], v[140:143], v[128:131], v[88:91]
    ds_read_b64_tr_b16 v[192:193], v213 offset:46336
    v_mfma_f32_16x16x32_bf16 v[92:95], v[140:143], v[132:135], v[92:95]
    ds_read_b64_tr_b16 v[194:195], v213 offset:50944
    s_waitcnt lgkmcnt(15)
    v_mfma_f32_16x16x32_bf16 v[32:35], v[148:151], v[164:167], v[32:35]
    ds_read_b128 v[96:99], v217 offset:208
    v_mfma_f32_16x16x32_bf16 v[36:39], v[24:27], v[164:167], v[36:39]
    ds_read_b64_tr_b16 v[200:201], v213 offset:55552
    v_mfma_f32_16x16x32_bf16 v[40:43], v[148:151], v[188:191], v[40:43]
    ds_read_b64_tr_b16 v[202:203], v213 offset:60160
    v_mfma_f32_16x16x32_bf16 v[44:47], v[24:27], v[188:191], v[44:47]
    ds_read_b128 v[204:207], v217 offset:224
    v_mfma_f32_16x16x32_bf16 v[48:51], v[148:151], v[208:211], v[48:51]
    ds_read_b64_tr_b16 v[196:197], v223 offset:256
    v_mfma_f32_16x16x32_bf16 v[52:55], v[24:27], v[208:211], v[52:55]
    ds_read_b64_tr_b16 v[198:199], v223 offset:4864
    s_waitcnt lgkmcnt(15)
    v_mfma_f32_16x16x32_bf16 v[88:91], v[156:159], v[132:135], v[88:91]
    ds_read_b128 v[224:227], v217 offset:240
    v_mfma_f32_16x16x32_bf16 v[92:95], v[156:159], v[160:163], v[92:95]
    ds_read_b64_tr_b16 v[100:101], v223 offset:9472
    v_mfma_f32_16x16x32_bf16 v[32:35], v[152:155], v[188:191], v[32:35]
    ds_read_b64_tr_b16 v[102:103], v223 offset:14080
    v_mfma_f32_16x16x32_bf16 v[36:39], v[168:171], v[188:191], v[36:39]
    ds_read_b128 v[232:235], v217 offset:256
    v_mfma_f32_16x16x32_bf16 v[40:43], v[152:155], v[208:211], v[40:43]
    ds_read_b64_tr_b16 v[236:237], v212 offset:46080
    v_mfma_f32_16x16x32_bf16 v[44:47], v[168:171], v[208:211], v[44:47]
    ds_read_b64_tr_b16 v[238:239], v212 offset:50688
    v_mfma_f32_16x16x32_bf16 v[48:51], v[152:155], v[8:11], v[48:51]
    ds_read_b64_tr_b16 v[228:229], v212 offset:46112
    v_mfma_f32_16x16x32_bf16 v[52:55], v[168:171], v[8:11], v[52:55]
    ds_read_b64_tr_b16 v[230:231], v212 offset:50720
    s_waitcnt lgkmcnt(15)
    v_mfma_f32_16x16x32_bf16 v[88:91], v[28:31], v[160:163], v[88:91]
    ds_read_b64_tr_b16 v[4:5], v212 offset:55296
    v_mfma_f32_16x16x32_bf16 v[92:95], v[28:31], v[180:183], v[92:95]
    ds_read_b64_tr_b16 v[6:7], v212 offset:59904
    v_mfma_f32_16x16x32_bf16 v[32:35], v[184:187], v[208:211], v[32:35]
    ds_read_b64_tr_b16 v[124:125], v212 offset:55328
    v_mfma_f32_16x16x32_bf16 v[36:39], v[176:179], v[208:211], v[36:39]
    ds_read_b64_tr_b16 v[126:127], v212 offset:59936
    v_mfma_f32_16x16x32_bf16 v[40:43], v[184:187], v[8:11], v[40:43]
    ds_read_b64_tr_b16 v[108:109], v222 offset:0
    v_mfma_f32_16x16x32_bf16 v[44:47], v[176:179], v[8:11], v[44:47]
    ds_read_b64_tr_b16 v[110:111], v222 offset:4608
    v_mfma_f32_16x16x32_bf16 v[48:51], v[184:187], v[16:19], v[48:51]
    ds_read_b128 v[104:107], v216 offset:224
    v_mfma_f32_16x16x32_bf16 v[52:55], v[176:179], v[16:19], v[52:55]
    ds_read_b64_tr_b16 v[12:13], v222 offset:32
    s_waitcnt lgkmcnt(15)
    v_mfma_f32_16x16x32_bf16 v[88:91], v[192:195], v[180:183], v[88:91]
    ds_read_b64_tr_b16 v[14:15], v222 offset:4640
    v_mfma_f32_16x16x32_bf16 v[92:95], v[192:195], v[96:99], v[92:95]
    ds_read_b64_tr_b16 v[116:117], v222 offset:9216
    v_mfma_f32_16x16x32_bf16 v[88:91], v[200:203], v[96:99], v[88:91]
    ds_read_b64_tr_b16 v[118:119], v222 offset:13824
    v_mfma_f32_16x16x32_bf16 v[92:95], v[200:203], v[204:207], v[92:95]
    ds_read_b128 v[120:123], v216 offset:240
    v_mfma_f32_16x16x32_bf16 v[88:91], v[196:199], v[204:207], v[88:91]
    ds_read_b64_tr_b16 v[112:113], v222 offset:9248
    v_mfma_f32_16x16x32_bf16 v[92:95], v[196:199], v[224:227], v[92:95]
    buffer_store_dword v1, v254, s[40:43], s28 offen offset:0 sc1
    s_waitcnt lgkmcnt(15)
    v_mfma_f32_16x16x32_bf16 v[88:91], v[100:103], v[224:227], v[88:91]
    ds_read_b64_tr_b16 v[114:115], v222 offset:13856
    s_nop 0
    v_mfma_f32_16x16x32_bf16 v[92:95], v[100:103], v[232:235], v[92:95]
    s_waitcnt lgkmcnt(14)
    s_nop 0
    v_mfma_f32_16x16x32_bf16 v[32:35], v[236:239], v[8:11], v[32:35]
    s_nop 1
    v_mfma_f32_16x16x32_bf16 v[36:39], v[228:231], v[8:11], v[36:39]
    v_cvt_pk_bf16_f32 v88, v88, v89
    v_cvt_pk_bf16_f32 v89, v90, v91
    s_waitcnt lgkmcnt(10)
    v_mfma_f32_16x16x32_bf16 v[32:35], v[4:7], v[16:19], v[32:35]
    v_cvt_pk_bf16_f32 v90, v92, v93
    v_cvt_pk_bf16_f32 v91, v94, v95
    v_mfma_f32_16x16x32_bf16 v[36:39], v[124:127], v[16:19], v[36:39]
    s_nop 0
    v_permlane32_swap_b32 v88, v90
    v_permlane32_swap_b32 v89, v91
    s_waitcnt lgkmcnt(5)
    v_mfma_f32_16x16x32_bf16 v[32:35], v[108:111], v[104:107], v[32:35]
    buffer_store_dwordx4 v[88:91], v241, s[40:43], s26 offen offset:2048 sc1
    v_mfma_f32_16x16x32_bf16 v[36:39], v[12:15], v[104:107], v[36:39]
    s_waitcnt lgkmcnt(0)
    v_mfma_f32_16x16x32_bf16 v[32:35], v[116:119], v[120:123], v[32:35]
    ds_read_b128 v[144:147], v216 offset:256
    s_nop 0
    v_mfma_f32_16x16x32_bf16 v[36:39], v[112:115], v[120:123], v[36:39]
    s_nop 1
    v_mfma_f32_16x16x32_bf16 v[40:43], v[236:239], v[16:19], v[40:43]
    s_nop 1
    v_mfma_f32_16x16x32_bf16 v[44:47], v[228:231], v[16:19], v[44:47]
    v_cvt_pk_bf16_f32 v32, v32, v33
    v_cvt_pk_bf16_f32 v33, v34, v35
    v_mfma_f32_16x16x32_bf16 v[40:43], v[4:7], v[104:107], v[40:43]
    v_cvt_pk_bf16_f32 v34, v36, v37
    v_cvt_pk_bf16_f32 v35, v38, v39
    v_mfma_f32_16x16x32_bf16 v[44:47], v[124:127], v[104:107], v[44:47]
    buffer_store_dwordx4 v[32:35], v240, s[40:43], s25 offen sc1
    s_add_u32 s25, s25, 41472
    v_mfma_f32_16x16x32_bf16 v[40:43], v[108:111], v[120:123], v[40:43]
    v_mfma_f32_16x16x32_bf16 v[44:47], v[12:15], v[120:123], v[44:47]
    s_waitcnt lgkmcnt(0)
    v_mfma_f32_16x16x32_bf16 v[40:43], v[116:119], v[144:147], v[40:43]
    ds_read_b128 v[128:131], v216 offset:272
    s_nop 0
    v_mfma_f32_16x16x32_bf16 v[44:47], v[112:115], v[144:147], v[44:47]
    s_nop 1
    v_mfma_f32_16x16x32_bf16 v[48:51], v[236:239], v[104:107], v[48:51]
    s_nop 1
    v_mfma_f32_16x16x32_bf16 v[52:55], v[228:231], v[104:107], v[52:55]
    v_cvt_pk_bf16_f32 v40, v40, v41
    v_cvt_pk_bf16_f32 v41, v42, v43
    v_mfma_f32_16x16x32_bf16 v[48:51], v[4:7], v[120:123], v[48:51]
    v_cvt_pk_bf16_f32 v42, v44, v45
    v_cvt_pk_bf16_f32 v43, v46, v47
    v_mfma_f32_16x16x32_bf16 v[52:55], v[124:127], v[120:123], v[52:55]
    buffer_store_dwordx4 v[40:43], v240, s[40:43], s25 offen sc1
    s_add_u32 s25, s25, 41472
    v_mfma_f32_16x16x32_bf16 v[48:51], v[108:111], v[144:147], v[48:51]
    v_mfma_f32_16x16x32_bf16 v[52:55], v[12:15], v[144:147], v[52:55]
    s_waitcnt lgkmcnt(0)
    v_mfma_f32_16x16x32_bf16 v[48:51], v[116:119], v[128:131], v[48:51]
    s_nop 1
    v_mfma_f32_16x16x32_bf16 v[52:55], v[112:115], v[128:131], v[52:55]
    s_nop 1
    v_mfma_f32_16x16x32_bf16 v[56:59], v[20:23], v[208:211], v[56:59]
    s_nop 1
    v_mfma_f32_16x16x32_bf16 v[60:63], v[136:139], v[208:211], v[60:63]
    v_cvt_pk_bf16_f32 v48, v48, v49
    v_cvt_pk_bf16_f32 v49, v50, v51
    v_mfma_f32_16x16x32_bf16 v[56:59], v[148:151], v[8:11], v[56:59]
    v_cvt_pk_bf16_f32 v50, v52, v53
    v_cvt_pk_bf16_f32 v51, v54, v55
    v_mfma_f32_16x16x32_bf16 v[60:63], v[24:27], v[8:11], v[60:63]
    buffer_store_dwordx4 v[48:51], v240, s[40:43], s25 offen sc1
    s_add_u32 s25, s25, 41472
    v_mfma_f32_16x16x32_bf16 v[56:59], v[152:155], v[16:19], v[56:59]
    v_mfma_f32_16x16x32_bf16 v[60:63], v[168:171], v[16:19], v[60:63]
    v_mfma_f32_16x16x32_bf16 v[56:59], v[184:187], v[104:107], v[56:59]
    ds_read_b128 v[140:143], v216 offset:288
    v_mfma_f32_16x16x32_bf16 v[60:63], v[176:179], v[104:107], v[60:63]
    v_mfma_f32_16x16x32_bf16 v[56:59], v[236:239], v[120:123], v[56:59]
    v_mfma_f32_16x16x32_bf16 v[60:63], v[228:231], v[120:123], v[60:63]
    v_mfma_f32_16x16x32_bf16 v[56:59], v[4:7], v[144:147], v[56:59]
    v_mfma_f32_16x16x32_bf16 v[60:63], v[124:127], v[144:147], v[60:63]
    v_mfma_f32_16x16x32_bf16 v[56:59], v[108:111], v[128:131], v[56:59]
    v_mfma_f32_16x16x32_bf16 v[60:63], v[12:15], v[128:131], v[60:63]
    s_waitcnt lgkmcnt(0)
    v_mfma_f32_16x16x32_bf16 v[56:59], v[116:119], v[140:143], v[56:59]
    s_nop 1
    v_mfma_f32_16x16x32_bf16 v[60:63], v[112:115], v[140:143], v[60:63]
    buffer_store_dword v1, v254, s[40:43], s28 offen offset:1152
    s_nop 0
    v_mfma_f32_16x16x32_bf16 v[64:67], v[20:23], v[8:11], v[64:67]
    s_nop 1
    v_mfma_f32_16x16x32_bf16 v[68:71], v[136:139], v[8:11], v[68:71]
    v_cvt_pk_bf16_f32 v56, v56, v57
    v_cvt_pk_bf16_f32 v57, v58, v59
    v_mfma_f32_16x16x32_bf16 v[64:67], v[148:151], v[16:19], v[64:67]
    v_cvt_pk_bf16_f32 v58, v60, v61
    v_cvt_pk_bf16_f32 v59, v62, v63
    v_mfma_f32_16x16x32_bf16 v[68:71], v[24:27], v[16:19], v[68:71]
    buffer_store_dwordx4 v[56:59], v240, s[40:43], s25 offen sc1
    s_add_u32 s25, s25, 41472
    v_mfma_f32_16x16x32_bf16 v[64:67], v[152:155], v[104:107], v[64:67]
    v_mfma_f32_16x16x32_bf16 v[68:71], v[168:171], v[104:107], v[68:71]
    buffer_store_dword v1, v254, s[40:43], s28 offen offset:2304 sc1
    v_mfma_f32_16x16x32_bf16 v[64:67], v[184:187], v[120:123], v[64:67]
    ds_read_b128 v[164:167], v216 offset:304
    v_mfma_f32_16x16x32_bf16 v[68:71], v[176:179], v[120:123], v[68:71]
    v_mfma_f32_16x16x32_bf16 v[64:67], v[236:239], v[144:147], v[64:67]
    v_mfma_f32_16x16x32_bf16 v[68:71], v[228:231], v[144:147], v[68:71]
    v_mfma_f32_16x16x32_bf16 v[64:67], v[4:7], v[128:131], v[64:67]
    v_mfma_f32_16x16x32_bf16 v[68:71], v[124:127], v[128:131], v[68:71]
    v_mfma_f32_16x16x32_bf16 v[64:67], v[108:111], v[140:143], v[64:67]
    v_mfma_f32_16x16x32_bf16 v[68:71], v[12:15], v[140:143], v[68:71]
    s_waitcnt lgkmcnt(0)
    v_mfma_f32_16x16x32_bf16 v[64:67], v[116:119], v[164:167], v[64:67]
    s_nop 1
    v_mfma_f32_16x16x32_bf16 v[68:71], v[112:115], v[164:167], v[68:71]
    buffer_store_dword v1, v254, s[40:43], s28 offen offset:1156
    s_nop 0
    v_mfma_f32_16x16x32_bf16 v[72:75], v[20:23], v[16:19], v[72:75]
    s_nop 1
    v_mfma_f32_16x16x32_bf16 v[76:79], v[136:139], v[16:19], v[76:79]
    v_cvt_pk_bf16_f32 v64, v64, v65
    v_cvt_pk_bf16_f32 v65, v66, v67
    v_mfma_f32_16x16x32_bf16 v[72:75], v[148:151], v[104:107], v[72:75]
    v_cvt_pk_bf16_f32 v66, v68, v69
    v_cvt_pk_bf16_f32 v67, v70, v71
    v_mfma_f32_16x16x32_bf16 v[76:79], v[24:27], v[104:107], v[76:79]
    buffer_store_dwordx4 v[64:67], v240, s[40:43], s25 offen sc1
    s_add_u32 s25, s25, 41472
    v_mfma_f32_16x16x32_bf16 v[72:75], v[152:155], v[120:123], v[72:75]
    v_mfma_f32_16x16x32_bf16 v[76:79], v[168:171], v[120:123], v[76:79]
    v_mfma_f32_16x16x32_bf16 v[72:75], v[184:187], v[144:147], v[72:75]
    ds_read_b128 v[132:135], v216 offset:320
    v_mfma_f32_16x16x32_bf16 v[76:79], v[176:179], v[144:147], v[76:79]
    v_mfma_f32_16x16x32_bf16 v[72:75], v[236:239], v[128:131], v[72:75]
    v_mfma_f32_16x16x32_bf16 v[76:79], v[228:231], v[128:131], v[76:79]
    v_mfma_f32_16x16x32_bf16 v[72:75], v[4:7], v[140:143], v[72:75]
    v_mfma_f32_16x16x32_bf16 v[76:79], v[124:127], v[140:143], v[76:79]
    v_mfma_f32_16x16x32_bf16 v[72:75], v[108:111], v[164:167], v[72:75]
    v_mfma_f32_16x16x32_bf16 v[76:79], v[12:15], v[164:167], v[76:79]
    buffer_store_dword v1, v254, s[40:43], s28 offen offset:1160
    s_waitcnt lgkmcnt(0)
    v_mfma_f32_16x16x32_bf16 v[72:75], v[116:119], v[132:135], v[72:75]
    s_nop 1
    v_mfma_f32_16x16x32_bf16 v[76:79], v[112:115], v[132:135], v[76:79]
    s_nop 1
    v_mfma_f32_16x16x32_bf16 v[80:83], v[20:23], v[104:107], v[80:83]
    s_nop 1
    v_mfma_f32_16x16x32_bf16 v[84:87], v[136:139], v[104:107], v[84:87]
    v_cvt_pk_bf16_f32 v72, v72, v73
    v_cvt_pk_bf16_f32 v73, v74, v75
    v_mfma_f32_16x16x32_bf16 v[80:83], v[148:151], v[120:123], v[80:83]
    v_cvt_pk_bf16_f32 v74, v76, v77
    v_cvt_pk_bf16_f32 v75, v78, v79
    v_mfma_f32_16x16x32_bf16 v[84:87], v[24:27], v[120:123], v[84:87]
    buffer_store_dwordx4 v[72:75], v240, s[40:43], s25 offen sc1
    s_add_u32 s25, s25, 41472
    v_mfma_f32_16x16x32_bf16 v[80:83], v[152:155], v[144:147], v[80:83]
    v_mfma_f32_16x16x32_bf16 v[84:87], v[168:171], v[144:147], v[84:87]
    v_mfma_f32_16x16x32_bf16 v[80:83], v[184:187], v[128:131], v[80:83]
    ds_read_b128 v[156:159], v216 offset:336
    v_mfma_f32_16x16x32_bf16 v[84:87], v[176:179], v[128:131], v[84:87]
    v_mfma_f32_16x16x32_bf16 v[80:83], v[236:239], v[140:143], v[80:83]
    v_mfma_f32_16x16x32_bf16 v[84:87], v[228:231], v[140:143], v[84:87]
    v_mfma_f32_16x16x32_bf16 v[80:83], v[4:7], v[164:167], v[80:83]
    v_mfma_f32_16x16x32_bf16 v[84:87], v[124:127], v[164:167], v[84:87]
    v_mfma_f32_16x16x32_bf16 v[80:83], v[108:111], v[132:135], v[80:83]
    v_mfma_f32_16x16x32_bf16 v[84:87], v[12:15], v[132:135], v[84:87]
    s_waitcnt lgkmcnt(0)
    v_mfma_f32_16x16x32_bf16 v[80:83], v[116:119], v[156:159], v[80:83]
    s_nop 1
    v_mfma_f32_16x16x32_bf16 v[84:87], v[112:115], v[156:159], v[84:87]
    s_nop 4
    v_cvt_pk_bf16_f32 v80, v80, v81
    v_cvt_pk_bf16_f32 v81, v82, v83
    s_nop 0
    v_cvt_pk_bf16_f32 v82, v84, v85
    v_cvt_pk_bf16_f32 v83, v86, v87
    buffer_store_dwordx4 v[80:83], v240, s[40:43], s25 offen sc1
L_fin:
L_ccommon:
    s_barrier
L_gatm:
    buffer_load_dwordx4 v[96:99], v242, s[40:43], s20 offen sc1
    buffer_load_dwordx4 v[100:103], v242, s[40:43], s21 offen sc1
    buffer_load_dwordx4 v[104:107], v242, s[40:43], s22 offen sc1
    buffer_load_dwordx4 v[108:111], v242, s[40:43], s23 offen sc1
    buffer_load_dwordx4 v[112:115], v243, s[40:43], s24 offen sc1
    v_mov_b32 v4, 152576
    ds_read_b32 v4, v4
    ds_read_b64_tr_b16 v[32:33], v175 offset:0
    ds_read_b64_tr_b16 v[34:35], v175 offset:4608
    ds_read_b64_tr_b16 v[36:37], v175 offset:32
    ds_read_b64_tr_b16 v[38:39], v175 offset:4640
    ds_read_b64_tr_b16 v[44:45], v175 offset:9216
    ds_read_b64_tr_b16 v[46:47], v175 offset:13824
    ds_read_b64_tr_b16 v[48:49], v175 offset:9248
    ds_read_b64_tr_b16 v[50:51], v175 offset:13856
    ds_read_b64_tr_b16 v[56:57], v175 offset:18432
    ds_read_b64_tr_b16 v[58:59], v175 offset:23040
    ds_read_b64_tr_b16 v[60:61], v175 offset:18464
    ds_read_b64_tr_b16 v[62:63], v175 offset:23072
    ds_read_b64_tr_b16 v[68:69], v175 offset:27648
    ds_read_b64_tr_b16 v[70:71], v175 offset:32256
    ds_read_b64_tr_b16 v[72:73], v175 offset:27680
    ds_read_b64_tr_b16 v[74:75], v175 offset:32288
    ds_read_b64_tr_b16 v[80:81], v175 offset:36864
    ds_read_b64_tr_b16 v[82:83], v175 offset:36896
    s_setprio 1
    s_mov_b32 s58, 0x4038aa3b
    s_mov_b32 s59, s58
    s_waitcnt lgkmcnt(0)
    v_readfirstlane_b32 s27, v4
L_shdm:
    s_waitcnt vmcnt(4)
    v_mfma_f32_16x16x32_bf16 v[16:19], v[244:247], v[96:99], 0
    s_waitcnt vmcnt(3)
    v_mfma_f32_16x16x32_bf16 v[16:19], v[244:247], v[100:103], v[16:19]
    s_waitcnt vmcnt(2)
    v_mfma_f32_16x16x32_bf16 v[16:19], v[244:247], v[104:107], v[16:19]
    s_waitcnt vmcnt(1)
    v_mfma_f32_16x16x32_bf16 v[16:19], v[244:247], v[108:111], v[16:19]
    s_waitcnt vmcnt(0)
    v_mfma_f32_16x16x32_bf16 v[16:19], v[244:247], v[112:115], v[16:19]
    s_nop 7
    v_cmp_u_f32 vcc, v16, v16
L_gelum:
    v_pk_mul_f32 v[20:21], v[16:17], v[16:17]
    v_pk_mul_f32 v[22:23], v[18:19], v[18:19]
    v_pk_fma_f32 v[20:21], v[20:21], s[60:61], v[220:221]
    v_pk_fma_f32 v[22:23], v[22:23], s[60:61], v[220:221]
    v_pk_mul_f32 v[20:21], v[20:21], v[16:17]
    v_pk_mul_f32 v[22:23], v[22:23], v[18:19]
    s_cbranch_vccnz L_slowm
    v_exp_f32 v20, v20
    v_exp_f32 v21, v21
    v_exp_f32 v22, v22
    v_exp_f32 v23, v23
    v_pk_add_f32 v[20:21], v[20:21], 1.0 op_sel_hi:[1,0]
    v_pk_add_f32 v[22:23], v[22:23], 1.0 op_sel_hi:[1,0]
    v_rcp_f32 v20, v20
    v_rcp_f32 v21, v21
    v_rcp_f32 v22, v22
    v_rcp_f32 v23, v23
    v_pk_mul_f32 v[16:17], v[16:17], v[20:21]
    v_pk_mul_f32 v[18:19], v[18:19], v[22:23]
    v_cvt_pk_bf16_f32 v16, v16, v17
    v_cvt_pk_bf16_f32 v17, v18, v19
    ds_write_b64 v248, v[16:17]
    s_mov_b32 vcc_lo, 0xff00ff00
    s_mov_b32 vcc_hi, vcc_lo
    s_cmp_eq_u32 s27, 2
    s_waitcnt lgkmcnt(0)
    s_barrier
    ds_read_b64 v[112:113], v250
    ds_read_b128 v[96:99], v249 offset:0
    ds_read_b128 v[100:103], v249 offset:512
    ds_read_b128 v[104:107], v249 offset:1024
    ds_read_b128 v[108:111], v249 offset:1536
    s_cbranch_scc1 L_cfb
    s_waitcnt lgkmcnt(4)
    v_mfma_f32_16x16x16_bf16 v[16:19], v[80:81], v[112:113], 0
    v_mfma_f32_16x16x16_bf16 v[20:23], v[82:83], v[112:113], 0
    s_waitcnt lgkmcnt(3)
    s_nop 3
    v_mfma_f32_16x16x32_bf16 v[16:19], v[32:35], v[96:99], v[16:19]
    s_waitcnt lgkmcnt(2)
    v_mfma_f32_16x16x32_bf16 v[16:19], v[44:47], v[100:103], v[16:19]
    s_waitcnt lgkmcnt(1)
    v_mfma_f32_16x16x32_bf16 v[16:19], v[56:59], v[104:107], v[16:19]
    s_waitcnt lgkmcnt(0)
    v_mfma_f32_16x16x32_bf16 v[16:19], v[68:71], v[108:111], v[16:19]
    s_nop 2
    v_mfma_f32_16x16x32_bf16 v[20:23], v[36:39], v[96:99], v[20:23]
    s_nop 2
    v_mfma_f32_16x16x32_bf16 v[20:23], v[48:51], v[100:103], v[20:23]
    v_cndmask_b32 v16, v16, v18, vcc
    v_cndmask_b32 v17, v17, v19, vcc
    v_mfma_f32_16x16x32_bf16 v[20:23], v[60:63], v[104:107], v[20:23]
    v_mul_f32 v16, s58, v16
    v_mul_f32 v17, s58, v17
    v_mfma_f32_16x16x32_bf16 v[20:23], v[72:75], v[108:111], v[20:23]
    v_exp_f32 v16, v16
    v_exp_f32 v17, v17
    s_nop 0
    ds_write_b64 v251, v[16:17] offset:0
    s_nop 3
    v_cndmask_b32 v20, v20, v22, vcc
    v_cndmask_b32 v21, v21, v23, vcc
    v_pk_mul_f32 v[20:21], v[20:21], s[58:59]
    v_exp_f32 v20, v20
    v_exp_f32 v21, v21
    s_nop 0
    ds_write_b64 v251, v[20:21] offset:256
L_cfd:
    s_waitcnt lgkmcnt(0)
    s_barrier
L_end:
    s_endpgm
L_help:
    s_and_b32 s48, s2, 7
    s_lshl_b32 s48, s48, 3
    s_mov_b32 s50, 0x261a0e00
    s_mov_b32 s51, 0x50463c32
    s_lshr_b64 s[50:51], s[50:51], s48
    s_and_b32 s50, s50, 255
    s_add_u32 s50, s50, s57
    s_mul_i32 s44, s50, 13108
    s_lshr_b32 s44, s44, 16
    s_mul_i32 s49, s44, 5
    s_sub_u32 s45, s50, s49
    s_add_u32 s45, s45, 9
    s_cmp_lt_u32 s46, 4
    s_cbranch_scc1 L_cw
    s_load_dwordx2 s[12:13], s[0:1], 16
    s_mov_b32 s14, 1285632
    s_mov_b32 s15, s7
    s_load_dwordx2 s[20:21], s[0:1], 32
    s_mov_b32 s22, 41472
    s_mov_b32 s23, s7
    s_load_dwordx2 s[24:25], s[0:1], 40
    s_mov_b32 s26, 41472
    s_mov_b32 s27, s7
    s_load_dwordx2 s[28:29], s[0:1], 48
    s_mov_b32 s30, 41472
    s_mov_b32 s31, s7
    s_load_dwordx2 s[32:33], s[0:1], 56
    s_mov_b32 s34, 2304000
    s_mov_b32 s35, s7
    s_load_dwordx2 s[36:37], s[0:1], 64
    s_mov_b32 s38, 256
    s_mov_b32 s39, s7
    s_load_dwordx2 s[40:41], s[0:1], 72
    s_mov_b32 s42, 6179328
    s_mov_b32 s43, s7
    s_mov_b32 s6, 2304000
    s_lshl_b32 s53, s2, 3
    v_bfrev_b32 v1, 1
    s_cmp_ge_u32 s57, 14
    s_cselect_b32 s48, 3, s47
    s_cmp_eq_u32 s48, 3
    s_cbranch_scc1 L_pfd
    s_cmp_eq_u32 s47, 2
    s_cbranch_scc1 L_pfx
    s_mov_b32 s50, 0x60606053
    s_mov_b32 s51, 0x74747474
    s_lshr_b64 s[50:51], s[50:51], s53
    s_and_b32 s50, s50, 255
    s_mul_i32 s48, s57, s50
    s_lshl_b32 s49, s47, 6
    v_add_u32 v3, s49, v0
    v_add_u32 v2, s48, v3
    v_mul_u32_u24 v4, 911, v2
    v_lshrrev_b32 v4, 16, v4
    v_mul_u32_u24 v4, 73728, v4
    v_lshl_add_u32 v2, v2, 7, v4
    v_cmp_gt_u32 vcc, s50, v3
    s_nop 1
    v_cndmask_b32 v2, v1, v2, vcc
    s_mov_b32 s48, 13824
    buffer_load_dword v5, v2, s[8:11], s48 offen
    s_mov_b32 s48, 23040
    buffer_load_dword v5, v2, s[8:11], s48 offen
    s_mov_b32 s48, 32256
    s_waitcnt vmcnt(1)
    buffer_load_dword v5, v2, s[8:11], s48 offen
    s_mov_b32 s48, 41472
    s_waitcnt vmcnt(1)
    buffer_load_dword v5, v2, s[8:11], s48 offen
    s_mov_b32 s48, 50688
    s_waitcnt vmcnt(1)
    buffer_load_dword v5, v2, s[8:11], s48 offen
    s_mov_b32 s48, 59904
    s_waitcnt vmcnt(1)
    buffer_load_dword v5, v2, s[8:11], s48 offen
    s_mov_b32 s48, 69120
    s_waitcnt vmcnt(1)
    buffer_load_dword v5, v2, s[8:11], s48 offen
    s_branch L_pfw2
L_pfx:
    s_mov_b32 s50, 0x6040200
    s_mov_b32 s51, 0xf0d0b08
    s_lshr_b64 s[50:51], s[50:51], s53
    s_and_b32 s50, s50, 255
    s_mul_i32 s48, s50, 112
    s_cmp_gt_u32 s50, 8
    s_cselect_b32 s49, -20, -12
    s_add_u32 s48, s48, s49
    s_mov_b32 s50, 0x1e1e1e12
    s_mov_b32 s51, 0x24242424
    s_lshr_b64 s[50:51], s[50:51], s53
    s_and_b32 s51, s50, 255
    s_mul_i32 s50, s57, s51
    s_add_u32 s48, s48, s50
    s_mul_i32 s48, s48, 1152
    v_mul_u32_u24 v2, 1152, v0
    v_add_u32 v2, s48, v2
    v_cmp_gt_u32 vcc, s51, v0
    v_min_u32 v2, v1, v2
    s_nop 0
    v_cndmask_b32 v2, v1, v2, vcc
    buffer_load_dword v5, v2, s[4:7], 0 offen offset:896
    buffer_load_dword v5, v2, s[4:7], 0 offen offset:384
    buffer_load_dword v5, v2, s[4:7], 0 offen offset:1024
    s_waitcnt vmcnt(1)
    buffer_load_dword v5, v2, s[4:7], 0 offen offset:512
    s_waitcnt vmcnt(1)
    buffer_load_dword v5, v2, s[4:7], 0 offen offset:1152
    s_waitcnt vmcnt(1)
    buffer_load_dword v5, v2, s[4:7], 0 offen offset:640
    s_waitcnt vmcnt(1)
    buffer_load_dword v5, v2, s[4:7], 0 offen offset:1280
L_pfw2:
    s_mul_i32 s48, s47, 10
    s_add_u32 s48, s48, s57
    s_lshl_b32 s48, s48, 13
    v_lshlrev_b32 v2, 7, v0
    s_waitcnt lgkmcnt(0)
L_pfd:
    v_lshlrev_b32 v42, 4, v0
    s_mul_i32 s52, s47, 10368
    v_add_u32 v42, s52, v42
    s_waitcnt lgkmcnt(0)
    s_cmp_lg_u32 s45, 9
    s_cbranch_scc1 L_lhelp2
    s_add_u32 m0, s52, 82944
    s_mov_b32 s48, 0
    buffer_load_dwordx4 v42, s[24:27], s48 offen lds
    buffer_load_dwordx4 v42, s[24:27], s48 offen offset:1024 lds
    buffer_load_dwordx4 v42, s[24:27], s48 offen offset:2048 lds
    buffer_load_dwordx4 v42, s[24:27], s48 offen offset:3072 lds
    s_add_u32 m0, s52, 87040
    s_mov_b32 s48, 4096
    buffer_load_dwordx4 v42, s[24:27], s48 offen lds
    buffer_load_dwordx4 v42, s[24:27], s48 offen offset:1024 lds
    buffer_load_dwordx4 v42, s[24:27], s48 offen offset:2048 lds
    buffer_load_dwordx4 v42, s[24:27], s48 offen offset:3072 lds
    s_add_u32 m0, s52, 91136
    s_mov_b32 s48, 8192
    buffer_load_dwordx4 v42, s[24:27], s48 offen lds
    buffer_load_dwordx4 v42, s[24:27], s48 offen offset:1024 lds
    s_mov_b64 exec, 0xff
    buffer_load_dwordx4 v42, s[24:27], s48 offen offset:2048 lds
    s_mov_b64 exec, -1
    s_waitcnt vmcnt(0)
    s_barrier
L_lhelp2:
    s_mul_i32 s48, s47, 10
    s_add_u32 s48, s48, s57
    s_cmp_ge_u32 s57, 10
    s_cselect_b32 s48, 30, s48
    s_cmp_ge_u32 s48, 30
    s_cselect_b32 s48, 0x4000, s48
    s_lshl_b32 s48, s48, 13
    v_lshlrev_b32 v2, 7, v0
    s_add_u32 s49, s48, 290304
    s_waitcnt vmcnt(0)
    buffer_load_dword v5, v2, s[12:15], s49 offen
    s_barrier
    s_add_u32 m0, s52, 0
    s_mov_b32 s48, 0
    buffer_load_dwordx4 v42, s[20:23], s48 offen lds
    buffer_load_dwordx4 v42, s[20:23], s48 offen offset:1024 lds
    buffer_load_dwordx4 v42, s[20:23], s48 offen offset:2048 lds
    buffer_load_dwordx4 v42, s[20:23], s48 offen offset:3072 lds
    s_add_u32 m0, s52, 4096
    s_mov_b32 s48, 4096
    buffer_load_dwordx4 v42, s[20:23], s48 offen lds
    buffer_load_dwordx4 v42, s[20:23], s48 offen offset:1024 lds
    buffer_load_dwordx4 v42, s[20:23], s48 offen offset:2048 lds
    buffer_load_dwordx4 v42, s[20:23], s48 offen offset:3072 lds
    s_add_u32 m0, s52, 8192
    s_mov_b32 s48, 8192
    buffer_load_dwordx4 v42, s[20:23], s48 offen lds
    buffer_load_dwordx4 v42, s[20:23], s48 offen offset:1024 lds
    s_mov_b64 exec, 0xff
    buffer_load_dwordx4 v42, s[20:23], s48 offen offset:2048 lds
    s_mov_b64 exec, -1
    s_add_u32 m0, s52, 41472
    s_mov_b32 s48, 6137856
    buffer_load_dwordx4 v42, s[40:43], s48 offen sc1 lds
    buffer_load_dwordx4 v42, s[40:43], s48 offen offset:1024 sc1 lds
    buffer_load_dwordx4 v42, s[40:43], s48 offen offset:2048 sc1 lds
    buffer_load_dwordx4 v42, s[40:43], s48 offen offset:3072 sc1 lds
    s_add_u32 m0, s52, 45568
    s_mov_b32 s48, 6141952
    buffer_load_dwordx4 v42, s[40:43], s48 offen sc1 lds
    buffer_load_dwordx4 v42, s[40:43], s48 offen offset:1024 sc1 lds
    buffer_load_dwordx4 v42, s[40:43], s48 offen offset:2048 sc1 lds
    buffer_load_dwordx4 v42, s[40:43], s48 offen offset:3072 sc1 lds
    s_add_u32 m0, s52, 49664
    s_mov_b32 s48, 6146048
    buffer_load_dwordx4 v42, s[40:43], s48 offen sc1 lds
    buffer_load_dwordx4 v42, s[40:43], s48 offen offset:1024 sc1 lds
    s_mov_b64 exec, 0xff
    buffer_load_dwordx4 v42, s[40:43], s48 offen offset:2048 sc1 lds
    s_mov_b64 exec, -1
    s_lshl_b32 s54, s44, 2
    s_mul_i32 s55, s44, 3584
    s_add_u32 s55, s55, 5557248
    v_mov_b32 v23, 0
    v_mov_b32 v6, 0
    v_mov_b32 v23, 0
    s_mov_b32 s49, 0
L_chkg:
    v_cmp_eq_u32 vcc, 0, v23
    s_add_u32 s49, s49, 1
    s_cbranch_vccz L_rdyg
    buffer_load_dword v23, v6, s[40:43], s55 offen offset:3456 sc1
    s_cmp_lt_u32 s49, 0x40000
    s_waitcnt vmcnt(0)
    s_cbranch_scc1 L_chkg
L_rdyg:
    s_and_b32 s51, s47, 1
    s_lshl_b32 s50, s51, 5
    s_lshl_b32 s51, s51, 8
    s_add_u32 s48, s50, 41472
    s_sub_u32 s49, 41728, s51
    v_lshrrev_b32 v1, 4, v0
    v_and_b32 v10, 15, v0
    v_lshlrev_b32 v10, 4, v10
    v_mul_u32_u24 v4, 1152, v1
    v_add3_u32 v14, v4, v10, s48
    v_add_u32 v8, v4, v14
    v_and_b32 v5, 7, v0
    v_mul_u32_u24 v5, 288, v5
    v_bfe_u32 v6, v0, 3, 1
    v_lshl_add_u32 v5, v6, 4, v5
    v_add3_u32 v15, v4, v5, s49
    v_add_u32 v9, v4, v15
    v_and_b32 v5, 1, v1
    v_mul_u32_u24 v5, 1144, v5
    v_sub_u32 v15, v15, v5
    v_sub_u32 v14, v14, v5
    s_cmp_gt_u32 s44, 8
    s_cselect_b32 s63, 9, 0
    s_sub_u32 s48, s44, s63
    s_lshl_b32 s48, s48, 1
    s_and_b32 s49, s45, 1
    s_add_u32 s48, s48, s49
    s_mul_i32 s48, s48, 56
    s_lshr_b32 s49, s45, 1
    s_add_u32 s48, s48, s49
    s_lshl3_add_u32 s48, s48, s47
    s_mul_i32 s48, s48, 288
    s_add_u32 s50, s48, s50
    s_sub_u32 s51, s48, s51
    v_and_b32 v5, 7, v0
    v_bfe_u32 v6, v0, 3, 1
    v_mul_u32_u24 v3, 16128, v5
    v_mul_u32_u24 v7, 1152, v6
    v_add3_u32 v3, v3, v7, s51
    v_lshl_add_u32 v3, v1, 3, v3
    v_lshlrev_b32 v2, 7, v1
    s_lshl4_add_u32 s48, s47, 147456
    v_lshl_add_u32 v18, v6, 6, s48
    v_add_u32 v18, v2, v18
    v_lshl_add_u32 v2, v5, 4, v2
    v_add_u32 v20, 126976, v2
    v_lshrrev_b32 v21, 1, v2
    v_add_u32 v21, 129024, v21
    v_lshrrev_b32 v19, 2, v0
    v_mul_u32_u24 v19, 288, v19
    v_and_b32 v7, 3, v0
    v_lshl_add_u32 v19, v7, 3, v19
    v_add_u32 v2, 131072, v2
    v_lshlrev_b32 v12, 6, v6
    v_lshl_add_u32 v12, v5, 3, v12
    v_and_b32 v13, 1, v1
    v_lshl_add_u32 v12, v13, 7, v12
    v_add_u32 v12, 129024, v12
    v_mul_u32_u24 v6, 2304, v1
    v_mul_u32_u24 v7, 64512, v13
    v_lshrrev_b32 v1, 1, v1
    v_mul_u32_u24 v1, 1152, v1
    v_add3_u32 v1, v1, v7, s50
    v_add_u32 v1, v1, v10
    v_add_u32 v10, 2048, v10
    v_lshl_add_u32 v13, v13, 3, v10
    v_cmp_gt_u32 vcc, 16, v0
    v_bfrev_b32 v7, 1
    s_nop 0
    v_cndmask_b32 v11, v7, v10, vcc
    v_add_u32 v10, v6, v10
    v_mov_b32 v27, 0
    v_and_b32 v55, 1, v5
    v_lshlrev_b32 v55, 4, v55
    s_movk_i32 s48, 0x3f80
    v_lshlrev_b32 v55, v55, s48
    v_lshrrev_b32 v5, 1, v5
    v_cmp_eq_u32 vcc, 0, v5
    s_nop 1
    v_cndmask_b32 v52, 0, v55, vcc
    v_cmp_eq_u32 vcc, 1, v5
    s_nop 1
    v_cndmask_b32 v53, 0, v55, vcc
    v_cmp_eq_u32 vcc, 2, v5
    s_nop 1
    v_cndmask_b32 v54, 0, v55, vcc
    v_cmp_eq_u32 vcc, 3, v5
    s_nop 1
    v_cndmask_b32 v55, 0, v55, vcc
    s_cmp_gt_u32 s45, 11
    s_cselect_b32 s48, 1, 0
    s_cselect_b32 s49, 0, 0
    s_lshl2_add_u32 s48, s48, 1156
    s_lshl2_add_u32 s49, s49, 2304
    s_cmp_gt_u32 s45, 8
    s_cselect_b32 s48, s48, 1152
    s_cselect_b32 s49, s49, 0
    s_mul_i32 s56, s44, 9
    s_sub_u32 s56, s56, s17
    s_lshr_b32 s16, s16, 1
    s_add_u32 s16, s16, 8
    v_add_u32 v5, s56, v0
    v_cmp_gt_u32 vcc, s16, v5
    v_lshl_add_u32 v5, v0, 7, s48
    v_lshl_add_u32 v22, v0, 7, s49
    v_cndmask_b32 v22, v22, v5, vcc
    s_mul_i32 s48, s44, 14
    s_add_u32 s48, s48, s45
    s_mul_i32 s16, s48, 20736
    s_add_u32 s17, s16, 9216
    s_add_u32 s18, s16, 18432
    v_mov_b32 v56, 0xc0135761
    v_mov_b32 v57, v56
    s_mov_b32 s63, 0
    s_cmp_eq_u32 s47, 0
    s_cselect_b32 s56, 0x1ff, 0
    s_bitset0_b32 s56, s45
    s_mov_b32 s57, 0
    v_and_b32 v24, 24, v0
    v_lshrrev_b32 v25, 5, v0
    v_lshl_add_u32 v24, v25, 2, v24
    v_and_b32 v25, 7, v0
    v_lshl_add_u32 v24, v24, 2, v25
    v_lshlrev_b32 v24, 4, v24
    v_lshlrev_b32 v25, 2, v0
    v_add_u32 v25, 152576, v25
    v_readfirstlane_b32 s27, v23
    ds_write_b32 v25, v23
    s_lshl1_add_u32 s24, s44, s27
    s_mul_i32 s24, s24, 9216
    s_cmp_gt_u32 s44, 8
    s_cselect_b32 s25, 128, 0
    s_add_u32 s24, s24, s25
    s_add_u32 s24, s24, 5216256
    s_lshl_b32 s26, s47, 7
    s_lshl1_add_u32 s25, s26, s24
    s_addk_i32 s25, 8192
    s_lshl4_add_u32 s24, s26, s24
    s_lshl3_add_u32 m0, s26, 147456
    s_nop 0
    buffer_load_dwordx4 v24, s[40:43], s24 offen sc1 lds
    s_add_u32 m0, s26, 151552
    s_mov_b64 exec, 0xff
    buffer_load_dwordx4 v24, s[40:43], s25 offen sc1 lds
    s_mov_b64 exec, -1
    s_branch L_lcommon
L_cbw:
    s_barrier
    s_branch L_ccommon
L_chelp:
    s_load_dwordx2 s[12:13], s[0:1], 16
    s_mov_b32 s14, 1285632
    s_mov_b32 s15, s7
    s_load_dwordx2 s[32:33], s[0:1], 48
    s_mov_b32 s34, 41472
    s_mov_b32 s35, s7
    s_cmp_lg_u32 s45, 9
    s_waitcnt vmcnt(0) lgkmcnt(0)
    s_cbranch_scc1 L_chelp2
    v_mul_u32_u24 v1, 288, v172
    v_lshl_add_u32 v1, v173, 3, v1
    buffer_load_dwordx2 v[96:97], v1, s[16:19], 0 offen offset:0
    buffer_load_dwordx2 v[98:99], v1, s[16:19], 0 offen offset:32
    buffer_load_dwordx2 v[100:101], v1, s[16:19], 0 offen offset:64
    buffer_load_dwordx2 v[102:103], v1, s[16:19], 0 offen offset:96
    buffer_load_dwordx2 v[104:105], v1, s[16:19], 0 offen offset:128
    buffer_load_dwordx2 v[106:107], v1, s[16:19], 0 offen offset:160
    buffer_load_dwordx2 v[108:109], v1, s[16:19], 0 offen offset:192
    buffer_load_dwordx2 v[110:111], v1, s[16:19], 0 offen offset:224
    buffer_load_dwordx2 v[112:113], v1, s[16:19], 0 offen offset:256
    v_add_u32 v2, 82944, v175
    v_add_u32 v3, 82944, v174
    s_cmp_lg_u32 s47, 1
    s_cbranch_scc1 L_wpd
    s_mul_i32 s48, s44, 2304
    s_add_u32 s49, s48, 6137856
    s_mov_b32 s50, 0x05040100
    s_mov_b32 s51, 0x07060302
    v_lshlrev_b32 v4, 4, v0
    v_mov_b32 v5, 1
    s_mov_b64 exec, 0x3ffff
    buffer_load_dwordx4 v[116:119], v4, s[32:35], s48 offen offset:0
    buffer_load_dwordx4 v[120:123], v4, s[32:35], s48 offen offset:288
    buffer_load_dwordx4 v[124:127], v4, s[32:35], s48 offen offset:576
    buffer_load_dwordx4 v[128:131], v4, s[32:35], s48 offen offset:864
    buffer_load_dwordx4 v[132:135], v4, s[32:35], s48 offen offset:1152
    buffer_load_dwordx4 v[136:139], v4, s[32:35], s48 offen offset:1440
    buffer_load_dwordx4 v[140:143], v4, s[32:35], s48 offen offset:1728
    buffer_load_dwordx4 v[144:147], v4, s[32:35], s48 offen offset:2016
    s_waitcnt vmcnt(0)
    v_perm_b32 v176, v120, v116, s50
    v_perm_b32 v177, v128, v124, s50
    v_perm_b32 v178, v136, v132, s50
    v_perm_b32 v179, v144, v140, s50
    buffer_store_dwordx4 v[176:179], v4, s[40:43], s49 offen offset:0 sc1
    v_perm_b32 v180, v120, v116, s51
    v_perm_b32 v181, v128, v124, s51
    v_perm_b32 v182, v136, v132, s51
    v_perm_b32 v183, v144, v140, s51
    buffer_store_dwordx4 v[180:183], v4, s[40:43], s49 offen offset:288 sc1
    v_perm_b32 v184, v121, v117, s50
    v_perm_b32 v185, v129, v125, s50
    v_perm_b32 v186, v137, v133, s50
    v_perm_b32 v187, v145, v141, s50
    buffer_store_dwordx4 v[184:187], v4, s[40:43], s49 offen offset:576 sc1
    v_perm_b32 v188, v121, v117, s51
    v_perm_b32 v189, v129, v125, s51
    v_perm_b32 v190, v137, v133, s51
    v_perm_b32 v191, v145, v141, s51
    buffer_store_dwordx4 v[188:191], v4, s[40:43], s49 offen offset:864 sc1
    v_perm_b32 v192, v122, v118, s50
    v_perm_b32 v193, v130, v126, s50
    v_perm_b32 v194, v138, v134, s50
    v_perm_b32 v195, v146, v142, s50
    buffer_store_dwordx4 v[192:195], v4, s[40:43], s49 offen offset:1152 sc1
    v_perm_b32 v196, v122, v118, s51
    v_perm_b32 v197, v130, v126, s51
    v_perm_b32 v198, v138, v134, s51
    v_perm_b32 v199, v146, v142, s51
    buffer_store_dwordx4 v[196:199], v4, s[40:43], s49 offen offset:1440 sc1
    v_perm_b32 v200, v123, v119, s50
    v_perm_b32 v201, v131, v127, s50
    v_perm_b32 v202, v139, v135, s50
    v_perm_b32 v203, v147, v143, s50
    buffer_store_dwordx4 v[200:203], v4, s[40:43], s49 offen offset:1728 sc1
    v_perm_b32 v204, v123, v119, s51
    v_perm_b32 v205, v131, v127, s51
    v_perm_b32 v206, v139, v135, s51
    v_perm_b32 v207, v147, v143, s51
    buffer_store_dwordx4 v[204:207], v4, s[40:43], s49 offen offset:2016 sc1
    s_lshl_b32 s48, s44, 2
    s_mov_b64 exec, 1
    s_waitcnt vmcnt(0)
    buffer_store_dword v5, off, s[36:39], s48 offset:72 sc1
    s_mov_b64 exec, -1
L_wpd:
    s_barrier
    ds_read_b64_tr_b16 v[32:33], v2 offset:0
    ds_read_b64_tr_b16 v[34:35], v2 offset:4608
    ds_read_b64_tr_b16 v[36:37], v2 offset:32
    ds_read_b64_tr_b16 v[38:39], v2 offset:4640
    ds_read_b64_tr_b16 v[40:41], v3 offset:256
    ds_read_b64_tr_b16 v[42:43], v3 offset:4864
    ds_read_b64_tr_b16 v[44:45], v2 offset:9216
    ds_read_b64_tr_b16 v[46:47], v2 offset:13824
    ds_read_b64_tr_b16 v[48:49], v2 offset:9248
    ds_read_b64_tr_b16 v[50:51], v2 offset:13856
    ds_read_b64_tr_b16 v[52:53], v3 offset:9472
    ds_read_b64_tr_b16 v[54:55], v3 offset:14080
    ds_read_b64_tr_b16 v[56:57], v2 offset:18432
    ds_read_b64_tr_b16 v[58:59], v2 offset:23040
    ds_read_b64_tr_b16 v[60:61], v2 offset:18464
    ds_read_b64_tr_b16 v[62:63], v2 offset:23072
    ds_read_b64_tr_b16 v[64:65], v3 offset:18688
    ds_read_b64_tr_b16 v[66:67], v3 offset:23296
    ds_read_b64_tr_b16 v[68:69], v2 offset:27648
    ds_read_b64_tr_b16 v[70:71], v2 offset:32256
    ds_read_b64_tr_b16 v[72:73], v2 offset:27680
    ds_read_b64_tr_b16 v[74:75], v2 offset:32288
    ds_read_b64_tr_b16 v[76:77], v3 offset:27904
    ds_read_b64_tr_b16 v[78:79], v3 offset:32512
    ds_read_b64_tr_b16 v[80:81], v2 offset:36864
    ds_read_b64_tr_b16 v[82:83], v2 offset:36896
    ds_read_b64_tr_b16 v[84:85], v3 offset:37120
    s_waitcnt vmcnt(0) lgkmcnt(0)
    v_mfma_f32_16x16x32_bf16 v[16:19], v[32:35], v[96:99], 0
    v_mfma_f32_16x16x32_bf16 v[20:23], v[36:39], v[96:99], 0
    v_mfma_f32_16x16x32_bf16 v[24:27], v[40:43], v[96:99], 0
    v_mfma_f32_16x16x32_bf16 v[16:19], v[44:47], v[100:103], v[16:19]
    v_mfma_f32_16x16x32_bf16 v[20:23], v[48:51], v[100:103], v[20:23]
    v_mfma_f32_16x16x32_bf16 v[24:27], v[52:55], v[100:103], v[24:27]
    v_mfma_f32_16x16x32_bf16 v[16:19], v[56:59], v[104:107], v[16:19]
    v_mfma_f32_16x16x32_bf16 v[20:23], v[60:63], v[104:107], v[20:23]
    v_mfma_f32_16x16x32_bf16 v[24:27], v[64:67], v[104:107], v[24:27]
    v_mfma_f32_16x16x32_bf16 v[16:19], v[68:71], v[108:111], v[16:19]
    v_mfma_f32_16x16x32_bf16 v[20:23], v[72:75], v[108:111], v[20:23]
    v_mfma_f32_16x16x32_bf16 v[24:27], v[76:79], v[108:111], v[24:27]
    s_nop 3
    v_mfma_f32_16x16x16_bf16 v[16:19], v[80:81], v[112:113], v[16:19]
    v_mfma_f32_16x16x16_bf16 v[20:23], v[82:83], v[112:113], v[20:23]
    v_mfma_f32_16x16x16_bf16 v[24:27], v[84:85], v[112:113], v[24:27]
    s_mov_b32 s58, 0x4038aa3b
    s_mov_b32 s59, 0x4038aa3b
    s_nop 3
    v_pk_mul_f32 v[16:17], v[16:17], s[58:59]
    v_pk_mul_f32 v[18:19], v[18:19], s[58:59]
    v_pk_mul_f32 v[20:21], v[20:21], s[58:59]
    v_pk_mul_f32 v[22:23], v[22:23], s[58:59]
    v_pk_mul_f32 v[24:25], v[24:25], s[58:59]
    v_pk_mul_f32 v[26:27], v[26:27], s[58:59]
    v_lshlrev_b32 v1, 4, v0
    s_mul_i32 s52, s44, 18432
    s_add_u32 s52, s52, 5225472
    s_add_u32 s53, s52, 8192
    s_lshl_b32 s48, s47, 11
    s_add_u32 s52, s52, s48
    s_cmp_eq_u32 s47, 0
    s_cselect_b32 s53, s53, 0x8000000
    v_add_u32 v2, 9216, v1
    s_lshl_b32 s48, s47, 2
    s_add_u32 s48, s48, 153600
    v_add_u32 v4, s48, v1
    v_max_f32 v3, |v16|, |v17|
    v_max3_f32 v3, |v18|, |v19|, v3
    v_max3_f32 v3, |v20|, |v21|, v3
    v_max3_f32 v3, |v22|, |v23|, v3
    v_max3_f32 v3, |v24|, |v25|, v3
    v_max3_f32 v3, |v26|, |v27|, v3
    ds_write_b32 v4, v3
    v_exp_f32 v32, v16
    v_exp_f32 v33, v17
    v_exp_f32 v34, v18
    v_exp_f32 v35, v19
    v_exp_f32 v36, v20
    v_exp_f32 v37, v21
    v_exp_f32 v38, v22
    v_exp_f32 v39, v23
    v_exp_f32 v40, v24
    v_exp_f32 v41, v25
    v_exp_f32 v42, v26
    v_exp_f32 v43, v27
    buffer_store_dwordx4 v[16:19], v2, s[40:43], s52 offen sc1
    buffer_store_dwordx4 v[20:23], v2, s[40:43], s52 offen offset:1024 sc1
    buffer_store_dwordx4 v[24:27], v2, s[40:43], s53 offen sc1
    buffer_store_dwordx4 v[32:35], v1, s[40:43], s52 offen sc1
    buffer_store_dwordx4 v[36:39], v1, s[40:43], s52 offen offset:1024 sc1
    buffer_store_dwordx4 v[40:43], v1, s[40:43], s53 offen sc1
    s_branch L_chelp3
L_chelp2:
    s_lshl_b32 s48, s46, 4
    s_add_u32 s48, s48, s45
    s_cmp_lg_u32 s48, 10
    s_cbranch_scc1 L_nozero
    v_lshlrev_b32 v1, 4, v0
    v_mov_b32 v4, 0
    v_mov_b32 v5, 0
    v_mov_b32 v6, 0
    v_mov_b32 v7, 0
    s_mul_i32 s48, s44, 3584
    s_add_u32 s48, s48, 5557248
    buffer_store_dwordx4 v[4:7], v1, s[40:43], s48 offen sc1
    buffer_store_dwordx4 v[4:7], v1, s[40:43], s48 offen offset:1024 sc1
    buffer_store_dwordx4 v[4:7], v1, s[40:43], s48 offen offset:2048 sc1
    buffer_store_dwordx4 v[4:7], v1, s[40:43], s48 offen offset:2560 sc1
    s_lshl_b32 s48, s44, 2
    v_mov_b32 v2, 1
    s_mov_b64 exec, 1
    s_waitcnt vmcnt(0)
    buffer_store_dword v2, off, s[36:39], s48 sc1
    s_mov_b64 exec, -1
L_nozero:
    s_mul_i32 s48, s44, 16
    s_lshl2_add_u32 s48, s45, s48
    s_add_u32 s48, s48, s47
    s_sub_u32 s48, s48, 40
    s_mul_i32 s48, s48, 18144
    v_lshlrev_b32 v1, 4, v0
    v_mov_b32 v4, 0xff81ff81
    v_mov_b32 v5, v4
    v_mov_b32 v6, v4
    v_mov_b32 v7, v4
    buffer_store_dwordx4 v[4:7], v1, s[40:43], s48 offen offset:0 sc1
    buffer_store_dwordx4 v[4:7], v1, s[40:43], s48 offen offset:1024 sc1
    buffer_store_dwordx4 v[4:7], v1, s[40:43], s48 offen offset:2048 sc1
    s_waitcnt vmcnt(2)
    buffer_store_dwordx4 v[4:7], v1, s[40:43], s48 offen offset:3072 sc1
    s_add_u32 s48, s48, 4096
    s_waitcnt vmcnt(2)
    buffer_store_dwordx4 v[4:7], v1, s[40:43], s48 offen offset:0 sc1
    s_waitcnt vmcnt(2)
    buffer_store_dwordx4 v[4:7], v1, s[40:43], s48 offen offset:1024 sc1
    s_waitcnt vmcnt(2)
    buffer_store_dwordx4 v[4:7], v1, s[40:43], s48 offen offset:2048 sc1
    s_waitcnt vmcnt(2)
    buffer_store_dwordx4 v[4:7], v1, s[40:43], s48 offen offset:3072 sc1
    s_add_u32 s48, s48, 4096
    s_waitcnt vmcnt(2)
    buffer_store_dwordx4 v[4:7], v1, s[40:43], s48 offen offset:0 sc1
    s_waitcnt vmcnt(2)
    buffer_store_dwordx4 v[4:7], v1, s[40:43], s48 offen offset:1024 sc1
    s_waitcnt vmcnt(2)
    buffer_store_dwordx4 v[4:7], v1, s[40:43], s48 offen offset:2048 sc1
    s_waitcnt vmcnt(2)
    buffer_store_dwordx4 v[4:7], v1, s[40:43], s48 offen offset:3072 sc1
    s_add_u32 s48, s48, 4096
    s_waitcnt vmcnt(2)
    buffer_store_dwordx4 v[4:7], v1, s[40:43], s48 offen offset:0 sc1
    s_waitcnt vmcnt(2)
    buffer_store_dwordx4 v[4:7], v1, s[40:43], s48 offen offset:1024 sc1
    s_waitcnt vmcnt(2)
    buffer_store_dwordx4 v[4:7], v1, s[40:43], s48 offen offset:2048 sc1
    s_waitcnt vmcnt(2)
    buffer_store_dwordx4 v[4:7], v1, s[40:43], s48 offen offset:3072 sc1
    s_add_u32 s48, s48, 4096
    s_waitcnt vmcnt(2)
    buffer_store_dwordx4 v[4:7], v1, s[40:43], s48 offen offset:0 sc1
    s_mov_b32 exec_hi, 0x3fff
    s_waitcnt vmcnt(2)
    buffer_store_dwordx4 v[4:7], v1, s[40:43], s48 offen offset:1024 sc1
    s_mov_b64 exec, -1
L_chelp3:
    s_nop 0
    v_min_u32 v5, 35, v0
    v_lshlrev_b32 v5, 2, v5
    v_mov_b32 v2, 1
    s_cmp_eq_u32 s46, 0
    s_cselect_b64 exec, -1, 0
    buffer_load_dword v2, v5, s[36:39], 0 offen sc1
    s_mov_b64 exec, -1
    s_mul_i32 s48, s44, 3584
    s_lshl2_add_u32 s48, s45, s48
    s_add_u32 s48, s48, 5560668
    s_waitcnt vmcnt(0) lgkmcnt(0)
    s_mov_b32 s49, 0
L_chkc:
    v_cmp_eq_u32 vcc, 0, v2
    s_add_u32 s49, s49, 1
    s_cbranch_vccz L_rdyc
    buffer_load_dword v2, v5, s[36:39], 0 offen sc1
    s_cmp_lt_u32 s49, 0x40000
    s_waitcnt vmcnt(0)
    s_cbranch_scc1 L_chkc
L_rdyc:
    s_barrier
    s_cmp_lg_u32 s46, 0
    s_cbranch_scc1 L_chelp4
    v_lshlrev_b32 v4, 4, v0
    v_add_u32 v4, 153600, v4
    ds_read_b128 v[4:7], v4
    s_waitcnt lgkmcnt(0)
    v_max3_f32 v4, v4, v5, v6
    v_max_f32 v4, v4, v7
    v_cmp_lt_f32 vcc, 0x42c80000, v4
    s_cmp_eq_u32 s45, 9
    s_cselect_b64 vcc, vcc, 0
    s_cmp_lg_u64 vcc, 0
    s_cselect_b32 s49, 2, 1
    v_mov_b32 v2, s49
    s_mov_b64 exec, 1
    buffer_store_dword v2, off, s[40:43], s48 sc1
    s_mov_b64 exec, -1
L_chelp4:
    s_lshl2_add_u32 s48, s57, s47
    s_lshl_b32 s48, s48, 13
    s_cmp_ge_u32 s57, 10
    s_cselect_b32 s48, 0x8000000, s48
    v_lshlrev_b32 v2, 7, v0
    s_add_u32 s48, s48, 622080
    buffer_load_dword v5, v2, s[12:15], s48 offen
    s_add_u32 s48, s48, 327680
    buffer_load_dword v5, v2, s[12:15], s48 offen
    s_add_u32 s48, s48, 327680
    s_waitcnt vmcnt(1)
    buffer_load_dword v5, v2, s[12:15], s48 offen
    s_waitcnt vmcnt(0)
    s_branch L_walk
L_eh:
    s_barrier
    ds_read_b64 v[238:239], v14 offset:36864
    ds_read_b64 v[240:241], v14 offset:37152
    ds_read_b64 v[242:243], v14 offset:37440
    ds_read_b64 v[244:245], v14 offset:37728
    ds_read_b64 v[246:247], v14 offset:38016
    ds_read_b64 v[248:249], v14 offset:38304
    ds_read_b64 v[250:251], v14 offset:38592
    ds_read_b64 v[252:253], v14 offset:38880
    ds_read_b128 v[94:97], v8 offset:0
    ds_read_b128 v[98:101], v8 offset:288
    ds_read_b128 v[102:105], v8 offset:576
    ds_read_b128 v[106:109], v8 offset:864
    ds_read_b128 v[110:113], v8 offset:1152
    ds_read_b128 v[114:117], v8 offset:1440
    ds_read_b128 v[118:121], v8 offset:1728
    ds_read_b128 v[122:125], v8 offset:2016
    ds_read_b128 v[130:133], v8 offset:9216
    ds_read_b128 v[134:137], v8 offset:9504
    ds_read_b128 v[138:141], v8 offset:9792
    ds_read_b128 v[142:145], v8 offset:10080
    ds_read_b128 v[146:149], v8 offset:10368
    ds_read_b128 v[150:153], v8 offset:10656
    ds_read_b128 v[154:157], v8 offset:10944
    ds_read_b128 v[158:161], v8 offset:11232
    ds_read_b128 v[166:169], v8 offset:18432
    ds_read_b128 v[170:173], v8 offset:18720
    ds_read_b128 v[174:177], v8 offset:19008
    ds_read_b128 v[178:181], v8 offset:19296
    ds_read_b128 v[182:185], v8 offset:19584
    ds_read_b128 v[186:189], v8 offset:19872
    ds_read_b128 v[190:193], v8 offset:20160
    ds_read_b128 v[194:197], v8 offset:20448
    ds_read_b128 v[202:205], v8 offset:27648
    ds_read_b128 v[206:209], v8 offset:27936
    ds_read_b128 v[210:213], v8 offset:28224
    ds_read_b128 v[214:217], v8 offset:28512
    ds_read_b128 v[218:221], v8 offset:28800
    ds_read_b128 v[222:225], v8 offset:29088
    ds_read_b128 v[226:229], v8 offset:29376
    ds_read_b128 v[230:233], v8 offset:29664
    ds_read_b128 v[126:129], v9 offset:0
    ds_read_b128 v[162:165], v9 offset:9216
    ds_read_b128 v[198:201], v9 offset:18432
    ds_read_b128 v[234:237], v9 offset:27648
    ds_read_b64 v[254:255], v15 offset:36864
    ds_read_b128 v[58:61], v18 offset:0
    ds_read_b128 v[62:65], v18 offset:512
    ds_read_b128 v[66:69], v18 offset:1024
    ds_read_b128 v[70:73], v18 offset:1536
    ds_read_b128 v[74:77], v18 offset:2048
    ds_read_b128 v[78:81], v18 offset:2560
    ds_read_b128 v[82:85], v18 offset:3072
    ds_read_b128 v[86:89], v18 offset:3584
    ds_read_b128 v[90:93], v18 offset:4096
    ds_read_b64_tr_b16 v[4:5], v19 offset:256
    ds_read_b64_tr_b16 v[6:7], v19 offset:4864
    ds_read_b64_tr_b16 v[14:15], v19 offset:9472
    ds_read_b64_tr_b16 v[16:17], v19 offset:14080
    ds_read_b64_tr_b16 v[36:37], v19 offset:18688
    ds_read_b64_tr_b16 v[38:39], v19 offset:23296
    ds_read_b64_tr_b16 v[40:41], v19 offset:27904
    ds_read_b64_tr_b16 v[42:43], v19 offset:32512
    ds_read_b64_tr_b16 v[18:19], v19 offset:37120
    s_branch L_ehd
L_slowx:
    s_mov_b32 s48, 0xff81ff81
    s_mov_b64 s[50:51], 0
    v_cmp_eq_u32 vcc, s48, v24
    s_or_b64 s[50:51], s[50:51], vcc
    v_cmp_eq_u32 vcc, s48, v25
    s_or_b64 s[50:51], s[50:51], vcc
    v_cmp_eq_u32 vcc, s48, v26
    s_or_b64 s[50:51], s[50:51], vcc
    v_cmp_eq_u32 vcc, s48, v27
    s_or_b64 s[50:51], s[50:51], vcc
    v_cmp_eq_u32 vcc, s48, v28
    s_or_b64 s[50:51], s[50:51], vcc
    v_cmp_eq_u32 vcc, s48, v29
    s_or_b64 s[50:51], s[50:51], vcc
    v_cmp_eq_u32 vcc, s48, v30
    s_or_b64 s[50:51], s[50:51], vcc
    v_cmp_eq_u32 vcc, s48, v31
    s_or_b64 s[50:51], s[50:51], vcc
    v_cmp_eq_u32 vcc, s48, v32
    s_or_b64 s[50:51], s[50:51], vcc
    v_cmp_eq_u32 vcc, s48, v33
    s_or_b64 s[50:51], s[50:51], vcc
    v_cmp_eq_u32 vcc, s48, v34
    s_or_b64 s[50:51], s[50:51], vcc
    v_cmp_eq_u32 vcc, s48, v35
    s_or_b64 s[50:51], s[50:51], vcc
    s_add_u32 s63, s63, 1
    s_cmp_lt_u32 s63, 0x10000
    s_cselect_b64 vcc, s[50:51], 0
    s_cbranch_vccnz L_agx
    s_mov_b32 s48, s16
    buffer_load_dwordx2 v[22:23], v13, s[40:43], s48 offen sc1
    buffer_load_dwordx2 v[24:25], v13, s[40:43], s48 offen offset:2304 sc1
    s_add_u32 s48, s48, 4608
    buffer_load_dwordx2 v[26:27], v13, s[40:43], s48 offen sc1
    buffer_load_dwordx2 v[28:29], v13, s[40:43], s48 offen offset:2304 sc1
    s_add_u32 s48, s48, 4608
    buffer_load_dwordx2 v[30:31], v13, s[40:43], s48 offen sc1
    buffer_load_dwordx2 v[32:33], v13, s[40:43], s48 offen offset:2304 sc1
    s_add_u32 s48, s48, 4608
    buffer_load_dwordx2 v[34:35], v13, s[40:43], s48 offen sc1
    buffer_load_dwordx2 v[52:53], v13, s[40:43], s48 offen offset:2304 sc1
    s_add_u32 s48, s48, 4608
    buffer_load_dwordx2 v[54:55], v13, s[40:43], s48 offen sc1
    s_mov_b32 s49, 0xffff0000
    s_waitcnt vmcnt(0)
    v_lshlrev_b32 v44, 16, v22
    v_and_b32 v45, s49, v22
    v_lshlrev_b32 v46, 16, v23
    v_and_b32 v47, s49, v23
    v_lshlrev_b32 v48, 16, v24
    v_and_b32 v49, s49, v24
    v_lshlrev_b32 v50, 16, v25
    v_and_b32 v51, s49, v25
    v_pk_add_f32 v[44:45], v[44:45], v[48:49]
    v_pk_add_f32 v[46:47], v[46:47], v[50:51]
    v_lshlrev_b32 v48, 16, v26
    v_and_b32 v49, s49, v26
    v_lshlrev_b32 v50, 16, v27
    v_and_b32 v51, s49, v27
    v_pk_add_f32 v[44:45], v[44:45], v[48:49]
    v_pk_add_f32 v[46:47], v[46:47], v[50:51]
    v_lshlrev_b32 v48, 16, v28
    v_and_b32 v49, s49, v28
    v_lshlrev_b32 v50, 16, v29
    v_and_b32 v51, s49, v29
    v_pk_add_f32 v[44:45], v[44:45], v[48:49]
    v_pk_add_f32 v[46:47], v[46:47], v[50:51]
    v_lshlrev_b32 v48, 16, v30
    v_and_b32 v49, s49, v30
    v_lshlrev_b32 v50, 16, v31
    v_and_b32 v51, s49, v31
    v_pk_add_f32 v[44:45], v[44:45], v[48:49]
    v_pk_add_f32 v[46:47], v[46:47], v[50:51]
    v_lshlrev_b32 v48, 16, v32
    v_and_b32 v49, s49, v32
    v_lshlrev_b32 v50, 16, v33
    v_and_b32 v51, s49, v33
    v_pk_add_f32 v[44:45], v[44:45], v[48:49]
    v_pk_add_f32 v[46:47], v[46:47], v[50:51]
    v_lshlrev_b32 v48, 16, v34
    v_and_b32 v49, s49, v34
    v_lshlrev_b32 v50, 16, v35
    v_and_b32 v51, s49, v35
    v_pk_add_f32 v[44:45], v[44:45], v[48:49]
    v_pk_add_f32 v[46:47], v[46:47], v[50:51]
    v_lshlrev_b32 v48, 16, v52
    v_and_b32 v49, s49, v52
    v_lshlrev_b32 v50, 16, v53
    v_and_b32 v51, s49, v53
    v_pk_add_f32 v[44:45], v[44:45], v[48:49]
    v_pk_add_f32 v[46:47], v[46:47], v[50:51]
    v_lshlrev_b32 v48, 16, v54
    v_and_b32 v49, s49, v54
    v_lshlrev_b32 v50, 16, v55
    v_and_b32 v51, s49, v55
    v_pk_add_f32 v[44:45], v[44:45], v[48:49]
    v_pk_add_f32 v[46:47], v[46:47], v[50:51]
    s_branch L_gelux
L_agx:
    buffer_load_dwordx4 v[24:27], v10, s[40:43], s16 offen sc1
    buffer_load_dwordx4 v[28:31], v10, s[40:43], s17 offen sc1
    buffer_load_dwordx4 v[32:35], v11, s[40:43], s18 offen sc1
    s_branch L_shdx
L_fb:
    ds_read_b128 v[20:23], v2 offset:0
    ds_read_b128 v[24:27], v2 offset:512
    ds_read_b128 v[28:31], v2 offset:1024
    ds_read_b128 v[32:35], v2 offset:1536
    ds_read_b128 v[36:39], v2 offset:2048
    ds_read_b128 v[40:43], v2 offset:2560
    ds_read_b128 v[44:47], v2 offset:3072
    ds_read_b128 v[48:51], v2 offset:3584
    v_lshlrev_b32 v8, 4, v0
    v_mov_b32 v4, 1.0
    v_mov_b32 v5, 1.0
    v_mov_b32 v6, 1.0
    v_mov_b32 v7, 1.0
    ds_write_b128 v8, v[4:7] offset:0
    ds_write_b128 v8, v[4:7] offset:1024
    ds_write_b128 v8, v[4:7] offset:2048
    ds_write_b128 v8, v[4:7] offset:3072
    ds_write_b128 v8, v[4:7] offset:4096
    v_subrev_u32 v2, 131072, v2
    s_waitcnt lgkmcnt(0)
    v_pk_add_f32 v[58:59], v[58:59], v[20:21]
    v_pk_add_f32 v[60:61], v[60:61], v[22:23]
    v_pk_add_f32 v[62:63], v[62:63], v[24:25]
    v_pk_add_f32 v[64:65], v[64:65], v[26:27]
    v_pk_add_f32 v[66:67], v[66:67], v[28:29]
    v_pk_add_f32 v[68:69], v[68:69], v[30:31]
    v_pk_add_f32 v[70:71], v[70:71], v[32:33]
    v_pk_add_f32 v[72:73], v[72:73], v[34:35]
    v_pk_add_f32 v[74:75], v[74:75], v[36:37]
    v_pk_add_f32 v[76:77], v[76:77], v[38:39]
    v_pk_add_f32 v[78:79], v[78:79], v[40:41]
    v_pk_add_f32 v[80:81], v[80:81], v[42:43]
    v_pk_add_f32 v[82:83], v[82:83], v[44:45]
    v_pk_add_f32 v[84:85], v[84:85], v[46:47]
    v_pk_add_f32 v[86:87], v[86:87], v[48:49]
    v_pk_add_f32 v[88:89], v[88:89], v[50:51]
    v_exp_f32 v58, v58
    v_exp_f32 v59, v59
    v_exp_f32 v60, v60
    v_exp_f32 v61, v61
    v_exp_f32 v62, v62
    v_exp_f32 v63, v63
    v_exp_f32 v64, v64
    v_exp_f32 v65, v65
    v_exp_f32 v66, v66
    v_exp_f32 v67, v67
    v_exp_f32 v68, v68
    v_exp_f32 v69, v69
    v_exp_f32 v70, v70
    v_exp_f32 v71, v71
    v_exp_f32 v72, v72
    v_exp_f32 v73, v73
    v_exp_f32 v74, v74
    v_exp_f32 v75, v75
    v_exp_f32 v76, v76
    v_exp_f32 v77, v77
    v_exp_f32 v78, v78
    v_exp_f32 v79, v79
    v_exp_f32 v80, v80
    v_exp_f32 v81, v81
    v_exp_f32 v82, v82
    v_exp_f32 v83, v83
    v_exp_f32 v84, v84
    v_exp_f32 v85, v85
    v_exp_f32 v86, v86
    v_exp_f32 v87, v87
    v_exp_f32 v88, v88
    v_exp_f32 v89, v89
    s_branch L_out
L_fb8:
    v_add_f32 v52, v52, v90
    v_mov_b32 v90, 1.0
    v_add_f32 v53, v53, v91
    v_mov_b32 v91, 1.0
    v_add_f32 v54, v54, v92
    v_mov_b32 v92, 1.0
    v_add_f32 v55, v55, v93
    v_mov_b32 v93, 1.0
    s_branch L_fb8d
L_cfb:
    s_waitcnt lgkmcnt(4)
    v_mfma_f32_16x16x16_bf16 v[16:19], v[80:81], v[112:113], 0
    v_mfma_f32_16x16x16_bf16 v[20:23], v[82:83], v[112:113], 0
    s_waitcnt lgkmcnt(3)
    s_nop 3
    v_mfma_f32_16x16x32_bf16 v[16:19], v[32:35], v[96:99], v[16:19]
    s_waitcnt lgkmcnt(2)
    v_mfma_f32_16x16x32_bf16 v[16:19], v[44:47], v[100:103], v[16:19]
    s_waitcnt lgkmcnt(1)
    v_mfma_f32_16x16x32_bf16 v[16:19], v[56:59], v[104:107], v[16:19]
    s_waitcnt lgkmcnt(0)
    v_mfma_f32_16x16x32_bf16 v[16:19], v[68:71], v[108:111], v[16:19]
    s_nop 2
    v_mfma_f32_16x16x32_bf16 v[20:23], v[36:39], v[96:99], v[20:23]
    s_nop 2
    v_mfma_f32_16x16x32_bf16 v[20:23], v[48:51], v[100:103], v[20:23]
    v_cndmask_b32 v16, v16, v18, vcc
    v_cndmask_b32 v17, v17, v19, vcc
    v_mfma_f32_16x16x32_bf16 v[20:23], v[60:63], v[104:107], v[20:23]
    v_mul_f32 v16, s58, v16
    v_mul_f32 v17, s58, v17
    v_mfma_f32_16x16x32_bf16 v[20:23], v[72:75], v[108:111], v[20:23]
    ds_write_b64 v251, v[16:17] offset:0
    s_nop 6
    v_cndmask_b32 v20, v20, v22, vcc
    v_cndmask_b32 v21, v21, v23, vcc
    v_pk_mul_f32 v[20:21], v[20:21], s[58:59]
    ds_write_b64 v251, v[20:21] offset:256
    s_branch L_cfd
L_slowm:
    s_mov_b32 s48, 0xff81ff81
    s_mov_b64 s[50:51], 0
    v_cmp_eq_u32 vcc, s48, v96
    s_or_b64 s[50:51], s[50:51], vcc
    v_cmp_eq_u32 vcc, s48, v97
    s_or_b64 s[50:51], s[50:51], vcc
    v_cmp_eq_u32 vcc, s48, v98
    s_or_b64 s[50:51], s[50:51], vcc
    v_cmp_eq_u32 vcc, s48, v99
    s_or_b64 s[50:51], s[50:51], vcc
    v_cmp_eq_u32 vcc, s48, v100
    s_or_b64 s[50:51], s[50:51], vcc
    v_cmp_eq_u32 vcc, s48, v101
    s_or_b64 s[50:51], s[50:51], vcc
    v_cmp_eq_u32 vcc, s48, v102
    s_or_b64 s[50:51], s[50:51], vcc
    v_cmp_eq_u32 vcc, s48, v103
    s_or_b64 s[50:51], s[50:51], vcc
    v_cmp_eq_u32 vcc, s48, v104
    s_or_b64 s[50:51], s[50:51], vcc
    v_cmp_eq_u32 vcc, s48, v105
    s_or_b64 s[50:51], s[50:51], vcc
    v_cmp_eq_u32 vcc, s48, v106
    s_or_b64 s[50:51], s[50:51], vcc
    v_cmp_eq_u32 vcc, s48, v107
    s_or_b64 s[50:51], s[50:51], vcc
    v_cmp_eq_u32 vcc, s48, v108
    s_or_b64 s[50:51], s[50:51], vcc
    v_cmp_eq_u32 vcc, s48, v109
    s_or_b64 s[50:51], s[50:51], vcc
    v_cmp_eq_u32 vcc, s48, v110
    s_or_b64 s[50:51], s[50:51], vcc
    v_cmp_eq_u32 vcc, s48, v111
    s_or_b64 s[50:51], s[50:51], vcc
    v_cmp_eq_u32 vcc, s48, v112
    s_or_b64 s[50:51], s[50:51], vcc
    v_cmp_eq_u32 vcc, s48, v113
    s_or_b64 s[50:51], s[50:51], vcc
    v_cmp_eq_u32 vcc, s48, v114
    s_or_b64 s[50:51], s[50:51], vcc
    v_cmp_eq_u32 vcc, s48, v115
    s_or_b64 s[50:51], s[50:51], vcc
    s_add_u32 s63, s63, 1
    s_cmp_lt_u32 s63, 0x10000
    s_cselect_b64 vcc, s[50:51], 0
    s_cbranch_vccnz L_agm
    s_mov_b32 s48, s20
    buffer_load_dwordx2 v[96:97], v253, s[40:43], s48 offen sc1
    buffer_load_dwordx2 v[98:99], v253, s[40:43], s48 offen offset:2304 sc1
    s_add_u32 s48, s48, 4608
    buffer_load_dwordx2 v[100:101], v253, s[40:43], s48 offen sc1
    buffer_load_dwordx2 v[102:103], v253, s[40:43], s48 offen offset:2304 sc1
    s_add_u32 s48, s48, 4608
    buffer_load_dwordx2 v[104:105], v253, s[40:43], s48 offen sc1
    buffer_load_dwordx2 v[106:107], v253, s[40:43], s48 offen offset:2304 sc1
    s_add_u32 s48, s48, 4608
    buffer_load_dwordx2 v[108:109], v253, s[40:43], s48 offen sc1
    buffer_load_dwordx2 v[110:111], v253, s[40:43], s48 offen offset:2304 sc1
    s_add_u32 s48, s48, 4608
    buffer_load_dwordx2 v[112:113], v253, s[40:43], s48 offen sc1
    s_mov_b32 s49, 0xffff0000
    s_waitcnt vmcnt(0)
    v_lshlrev_b32 v16, 16, v96
    v_and_b32 v17, s49, v96
    v_lshlrev_b32 v18, 16, v97
    v_and_b32 v19, s49, v97
    v_lshlrev_b32 v20, 16, v98
    v_and_b32 v21, s49, v98
    v_lshlrev_b32 v22, 16, v99
    v_and_b32 v23, s49, v99
    v_pk_add_f32 v[16:17], v[16:17], v[20:21]
    v_pk_add_f32 v[18:19], v[18:19], v[22:23]
    v_lshlrev_b32 v20, 16, v100
    v_and_b32 v21, s49, v100
    v_lshlrev_b32 v22, 16, v101
    v_and_b32 v23, s49, v101
    v_pk_add_f32 v[16:17], v[16:17], v[20:21]
    v_pk_add_f32 v[18:19], v[18:19], v[22:23]
    v_lshlrev_b32 v20, 16, v102
    v_and_b32 v21, s49, v102
    v_lshlrev_b32 v22, 16, v103
    v_and_b32 v23, s49, v103
    v_pk_add_f32 v[16:17], v[16:17], v[20:21]
    v_pk_add_f32 v[18:19], v[18:19], v[22:23]
    v_lshlrev_b32 v20, 16, v104
    v_and_b32 v21, s49, v104
    v_lshlrev_b32 v22, 16, v105
    v_and_b32 v23, s49, v105
    v_pk_add_f32 v[16:17], v[16:17], v[20:21]
    v_pk_add_f32 v[18:19], v[18:19], v[22:23]
    v_lshlrev_b32 v20, 16, v106
    v_and_b32 v21, s49, v106
    v_lshlrev_b32 v22, 16, v107
    v_and_b32 v23, s49, v107
    v_pk_add_f32 v[16:17], v[16:17], v[20:21]
    v_pk_add_f32 v[18:19], v[18:19], v[22:23]
    v_lshlrev_b32 v20, 16, v108
    v_and_b32 v21, s49, v108
    v_lshlrev_b32 v22, 16, v109
    v_and_b32 v23, s49, v109
    v_pk_add_f32 v[16:17], v[16:17], v[20:21]
    v_pk_add_f32 v[18:19], v[18:19], v[22:23]
    v_lshlrev_b32 v20, 16, v110
    v_and_b32 v21, s49, v110
    v_lshlrev_b32 v22, 16, v111
    v_and_b32 v23, s49, v111
    v_pk_add_f32 v[16:17], v[16:17], v[20:21]
    v_pk_add_f32 v[18:19], v[18:19], v[22:23]
    v_lshlrev_b32 v20, 16, v112
    v_and_b32 v21, s49, v112
    v_lshlrev_b32 v22, 16, v113
    v_and_b32 v23, s49, v113
    v_pk_add_f32 v[16:17], v[16:17], v[20:21]
    v_pk_add_f32 v[18:19], v[18:19], v[22:23]
    s_branch L_gelum
L_agm:
    buffer_load_dwordx4 v[96:99], v242, s[40:43], s20 offen sc1
    buffer_load_dwordx4 v[100:103], v242, s[40:43], s21 offen sc1
    buffer_load_dwordx4 v[104:107], v242, s[40:43], s22 offen sc1
    buffer_load_dwordx4 v[108:111], v242, s[40:43], s23 offen sc1
    buffer_load_dwordx4 v[112:115], v243, s[40:43], s24 offen sc1
    s_branch L_shdm
.section .rodata,"a"
.p2align 6
.amdhsa_kernel standalone__seq2seq_rnn_t_joint__speech_kernel
  .amdhsa_next_free_vgpr 256
  .amdhsa_next_free_sgpr 102
  .amdhsa_accum_offset 256
  .amdhsa_group_segment_fixed_size 0
  .amdhsa_kernarg_size 80
  .amdhsa_user_sgpr_count 2
  .amdhsa_user_sgpr_kernarg_segment_ptr 1
  .amdhsa_system_sgpr_workgroup_id_x 1
.end_amdhsa_kernel
```
